```python
import torch

def _softmax(x, axis=-1):
    return torch.softmax(x, dim=axis)
def _gelu(x):
    return torch.nn.functional.gelu(x, approximate="tanh")
def _silu(x):
    return torch.nn.functional.silu(x)
def _sigmoid(x):
    return torch.sigmoid(x)
def _layernorm(x, axis=-1, eps=1e-5):
    m = x.mean(dim=axis, keepdim=True)
    v = x.var(dim=axis, keepdim=True, unbiased=False)
    return (x - m) / torch.sqrt(v + eps)
def _scatter_add(tgt, idx, src, axis=0):
    return tgt.clone().index_add_(axis, idx, src)
def _segment_sum(src, seg, n):
    out = torch.zeros((n,) + src.shape[1:], dtype=src.dtype)
    return out.index_add_(0, seg, src)
def _pad(x, pw):
    flat = tuple(v for pair in reversed(pw) for v in pair)
    return torch.nn.functional.pad(x, flat)

kernel_name = 'parallel_sum__compressed_kv_cla__dense_activation_silu__decode'

def setup_inputs():

    _w = (lambda a: (lambda t: t.to(torch.bfloat16) if t.is_floating_point() else t)(torch.as_tensor(a)))
    def _A_setup():
        B, H, Sq, Sk, D, M = 2, 32, 1, 8192, 128, 576
        Dc = 4 * D
        return {
            "x": _w((lambda *s: torch.randn(*s, dtype=torch.bfloat16) * 0.05)(B, Sq, M)),
            "c_kv": _w((lambda *s: torch.randn(*s, dtype=torch.bfloat16) * 0.8)(B, Sk, Dc)),
            "w_q": _w((lambda *s: torch.randn(*s, dtype=torch.bfloat16) * 3.2)(M, H, D) * (M ** -0.5)),
            "w_uk": _w((lambda *s: torch.randn(*s, dtype=torch.bfloat16) * 3.2)(Dc, H, D) * (Dc ** -0.5)),
            "w_uv": _w((lambda *s: torch.randn(*s, dtype=torch.bfloat16) * 0.8)(Dc, H, D) * (Dc ** -0.5)),
            "w_o": _w((lambda *s: torch.randn(*s, dtype=torch.bfloat16) * 0.8)(H, D, M) * ((H * D) ** -0.5)),
        }
    _A_in = _A_setup()

    def _B_setup():
        B, S, D, F = 2, 1, 576, 4608
        return {
            "x": _w((lambda *s: torch.randn(*s, dtype=torch.bfloat16) * 0.05)(B, S, D)),
            "w1": _w((lambda *s: torch.randn(*s, dtype=torch.bfloat16) * 3.2)(D, F) * (D ** -0.5)),
            "w2": _w((lambda *s: torch.randn(*s, dtype=torch.bfloat16) * 0.2)(F, D) * (F ** -0.5)),
        }
    _B_in = _B_setup()

    return {
        "A_x": _A_in["x"],
        "A_c_kv": _A_in["c_kv"],
        "A_w_q": _A_in["w_q"],
        "A_w_uk": _A_in["w_uk"],
        "A_w_uv": _A_in["w_uv"],
        "A_w_o": _A_in["w_o"],
        "B_x": _B_in["x"],
        "B_w1": _B_in["w1"],
        "B_w2": _B_in["w2"],
    }

def reference(A_x, A_c_kv, A_w_q, A_w_uk, A_w_uv, A_w_o, B_x, B_w1, B_w2):
    def _A_ref(x, c_kv, w_q, w_uk, w_uv, w_o):
        B, Sq, M = x.shape[0], x.shape[1], x.shape[2]
        Sk = c_kv.shape[1]
        H, D = w_q.shape[1], w_q.shape[2]
        q = torch.einsum("bqm,mhd->bhqd", x, w_q)
        k = torch.einsum("bkc,chd->bhkd", c_kv, w_uk)
        v = torch.einsum("bkc,chd->bhkd", c_kv, w_uv)
        scores = torch.einsum("bhqd,bhkd->bhqk", q, k) * (D ** -0.5)
        off = Sk - Sq
        qi = torch.arange(Sq)[:, None]
        kj = torch.arange(Sk)[None, :]
        cmask = kj <= (qi + off)
        scores = torch.where(cmask[None, None], scores, -1e9)
        p = _softmax(scores, axis=-1)
        ctx = torch.einsum("bhqk,bhkd->bhqd", p, v)
        return torch.einsum("bhqd,hdm->bqm", ctx, w_o)

    def _B_ref(x, w1, w2):
        h = torch.einsum("bsd,df->bsf", x, w1)
        h = _silu(h)
        out = torch.einsum("bsf,fd->bsd", h, w2)
        return out

    x = A_x
    xn = _layernorm(x, axis=-1)
    return x + _A_ref(xn, A_c_kv, A_w_q, A_w_uk, A_w_uv, A_w_o) + _B_ref(xn, B_w1, B_w2)
```

```asm
; @launch grid=(256,1,1) block=(256,1,1) lds=163840
.amdgcn_target "amdgcn-amd-amdhsa--gfx950"
.text
.globl parallel_sum__compressed_kv_cla__dense_activation_silu__decode_kernel
.p2align 12
.type parallel_sum__compressed_kv_cla__dense_activation_silu__decode_kernel,@function
parallel_sum__compressed_kv_cla__dense_activation_silu__decode_kernel:
s_cmp_ge_u32 s2, 256
s_cbranch_scc1 L_end
s_load_dwordx16 s[4:19], s[0:1], 0
s_load_dwordx8 s[20:27], s[0:1], 64
v_lshrrev_b32 v1, 6, v0
v_and_b32 v0, 63, v0
v_readfirstlane_b32 s3, v1
s_and_b32 s52, s2, 7
s_bfe_u32 s53, s2, 0x40003
s_mov_b32 s57, 0x40000
s_mov_b32 s100, 0xffff0000
v_lshlrev_b32 v3, 4, v0
v_lshrrev_b32 v1, 4, v0
v_and_b32 v2, 15, v0
s_cmp_ge_u32 s2, 128
s_cbranch_scc1 L_attn
s_lshr_b32 s54, s53, 2
s_lshl3_add_u32 s54, s54, s52
s_and_b32 s55, s53, 3
s_lshl4_add_u32 s67, s52, s53
s_mul_i32 s66, s3, 39296
v_lshrrev_b32 v12, 5, v0
v_and_b32 v13, 31, v0
v_mul_u32_u24 v12, 0x480, v12
v_mad_u32_u24 v5, v13, 36, v12
v_lshrrev_b32 v12, 2, v0
v_lshlrev_b32 v6, 13, v12
v_lshrrev_b32 v12, 4, v0
v_and_b32 v12, 2, v12
v_and_b32 v13, 3, v0
v_xor_b32 v12, v12, v13
v_lshl_add_u32 v6, v12, 4, v6
v_xor_b32 v12, v2, v1
v_lshlrev_b32 v12, 4, v12
v_lshl_add_u32 v66, v1, 13, v12
v_lshl_add_u32 v70, v2, 8, v12
v_xor_b32 v67, 64, v66
v_xor_b32 v71, 64, v70
v_xor_b32 v68, 128, v66
v_xor_b32 v72, 128, v70
v_xor_b32 v69, 192, v66
v_xor_b32 v73, 192, v70
v_add_u32 v70, s66, v70
v_add_u32 v71, s66, v71
v_add_u32 v72, s66, v72
v_add_u32 v73, s66, v73
s_mul_i32 s58, s55, 1179648
s_lshl_b32 s59, s54, 8
s_add_u32 s58, s58, s59
s_lshl_b32 s60, s3, 6
s_add_u32 s58, s58, s60
s_lshl2_add_u32 s60, s55, s3
s_lshl_b32 s60, s60, 18
s_add_u32 s64, s59, s60
s_add_u32 s65, s64, 131072
s_add_u32 s61, s66, 30080
v_mov_b32 v128, 0x3f803f80
v_mov_b32 v129, 0x3f803f80
v_mov_b32 v130, 0x3f803f80
v_mov_b32 v131, 0x3f803f80
v_mov_b32 v132, 0x3f803f80
v_mov_b32 v133, 0x3f803f80
v_mov_b32 v134, 0x3f803f80
v_mov_b32 v135, 0x3f803f80
v_mov_b32 v136, 0x3f803f80
v_mov_b32 v137, 0x3f803f80
v_mov_b32 v138, 0x3f803f80
v_mov_b32 v139, 0x3f803f80
v_mov_b32 v140, 0x3f803f80
v_mov_b32 v141, 0x3f803f80
v_mov_b32 v142, 0x3f803f80
v_mov_b32 v143, 0x3f803f80
v_mov_b32 v144, 0x3f803f80
v_mov_b32 v145, 0x3f803f80
v_bfe_u32 v13, v0, 2, 2
v_and_b32 v14, 3, v0
v_lshlrev_b32 v14, 3, v14
v_lshl_add_u32 v13, v13, 6, v14
v_add_u32 v13, s66, v13
v_lshl_add_u32 v8, v1, 9, v13
v_and_b32 v14, 1, v1
v_lshl_add_u32 v8, v14, 5, v8
v_xor_b32 v9, 32, v8
v_lshl_add_u32 v10, v1, 8, v13
v_lshrrev_b32 v14, 1, v1
v_lshl_add_u32 v10, v14, 5, v10
v_xor_b32 v11, 32, v10
v_and_b32 v14, 1, v2
v_mul_u32_u24 v14, 0x480, v14
v_lshl_add_u32 v12, v1, 4, v14
v_lshl_add_u32 v15, v1, 3, v14
s_mul_i32 s101, s55, 288
s_add_u32 s101, s101, s66
v_add_u32 v13, s101, v12
v_add_u32 v14, s101, v15
s_add_u32 s101, s66, 11520
v_add_u32 v112, s101, v5
v_and_b32 v30, 1, v2
v_lshlrev_b32 v64, 7, v30
v_bfe_u32 v30, v2, 1, 1
v_lshl_add_u32 v30, v30, 2, v1
v_lshl_add_u32 v64, v30, 4, v64
s_lshl_b32 s63, s54, 12
s_add_u32 s63, s63, 262144
s_waitcnt lgkmcnt(0)
s_load_dword s56, s[26:27], 0
s_mov_b32 s28, s4
s_mov_b32 s29, s5
s_mov_b32 s30, 0x900
s_mov_b32 s31, 0x20000
buffer_load_dwordx4 v[80:83], v5, s[28:31], 0 offen
buffer_load_dwordx4 v[84:87], v5, s[28:31], 0 offen offset:16
buffer_load_dword v88, v5, s[28:31], 0 offen offset:32
s_mov_b32 s32, s8
s_mov_b32 s33, s9
s_mov_b32 s34, 0x480000
s_mov_b32 s35, 0x20000
s_mov_b32 s36, s10
s_mov_b32 s37, s11
s_mov_b32 s38, 0x400000
s_mov_b32 s39, 0x20000
s_barrier
s_mov_b32 m0, s61
s_nop 0
buffer_load_dwordx4 v6, s[32:35], s58 offen lds
s_add_u32 m0, m0, 0x400
s_add_u32 s58, s58, 131072
buffer_load_dwordx4 v6, s[32:35], s58 offen lds
s_add_u32 m0, m0, 0x400
s_add_u32 s58, s58, 131072
buffer_load_dwordx4 v6, s[32:35], s58 offen lds
s_add_u32 m0, m0, 0x400
s_add_u32 s58, s58, 131072
buffer_load_dwordx4 v6, s[32:35], s58 offen lds
s_add_u32 m0, m0, 0x400
s_add_u32 s58, s58, 131072
buffer_load_dwordx4 v6, s[32:35], s58 offen lds
s_add_u32 m0, m0, 0x400
s_add_u32 s58, s58, 131072
buffer_load_dwordx4 v6, s[32:35], s58 offen lds
s_add_u32 m0, m0, 0x400
s_add_u32 s58, s58, 131072
buffer_load_dwordx4 v6, s[32:35], s58 offen lds
s_add_u32 m0, m0, 0x400
s_add_u32 s58, s58, 131072
buffer_load_dwordx4 v6, s[32:35], s58 offen lds
s_add_u32 m0, m0, 0x400
s_add_u32 s58, s58, 131072
buffer_load_dwordx4 v6, s[32:35], s58 offen lds
s_barrier
s_mov_b32 s40, s26
s_mov_b32 s41, s27
s_mov_b32 s42, 0xa00000
s_mov_b32 s43, 0x20000
s_mov_b32 s28, s18
s_mov_b32 s29, s19
s_mov_b32 s30, 0x510000
s_mov_b32 s31, 0x20000
s_mov_b32 s32, s20
s_mov_b32 s33, s21
s_mov_b32 s34, 0x510000
s_mov_b32 s35, 0x20000
s_mov_b32 s44, s14
s_mov_b32 s45, s15
s_mov_b32 s46, 0x480000
s_mov_b32 s47, 0x20000
s_mov_b32 s96, s12
s_mov_b32 s97, s13
s_lshl2_add_u32 s23, s53, s3
s_cmp_ge_u32 s23, 14
s_cbranch_scc1 L_backh
s_mov_b64 exec, 0
s_cmp_lt_u32 s23, 7
s_cbranch_scc0 L_wth7
s_cmp_lt_u32 s23, 3
s_cbranch_scc0 L_wth3
s_cmp_lt_u32 s23, 1
s_cbranch_scc0 L_wth1
s_branch L_padh0
L_wth1:
s_cmp_lt_u32 s23, 2
s_cbranch_scc0 L_wth2
s_branch L_padh1
L_wth2:
s_branch L_padh2
L_wth3:
s_cmp_lt_u32 s23, 5
s_cbranch_scc0 L_wth5
s_cmp_lt_u32 s23, 4
s_cbranch_scc0 L_wth4
s_branch L_padh3
L_wth4:
s_branch L_padh4
L_wth5:
s_cmp_lt_u32 s23, 6
s_cbranch_scc0 L_wth6
s_branch L_padh5
L_wth6:
s_branch L_padh6
L_wth7:
s_cmp_lt_u32 s23, 10
s_cbranch_scc0 L_wth10
s_cmp_lt_u32 s23, 8
s_cbranch_scc0 L_wth8
s_branch L_padh7
L_wth8:
s_cmp_lt_u32 s23, 9
s_cbranch_scc0 L_wth9
s_branch L_padh8
L_wth9:
s_branch L_padh9
L_wth10:
s_cmp_lt_u32 s23, 12
s_cbranch_scc0 L_wth12
s_cmp_lt_u32 s23, 11
s_cbranch_scc0 L_wth11
s_branch L_padh10
L_wth11:
s_branch L_padh11
L_wth12:
s_cmp_lt_u32 s23, 13
s_cbranch_scc0 L_wth13
s_branch L_padh12
L_wth13:
s_branch L_padh13
L_backh:
s_mov_b64 exec, -1
s_lshl2_add_u32 s62, s3, s55
s_lshl_b32 s62, s62, 8
s_add_u32 s62, s62, s63
v_and_b32 v30, 3, v2
v_lshlrev_b32 v65, 8, v30
v_bfe_u32 v30, v2, 2, 1
v_lshl_add_u32 v65, v30, 7, v65
v_lshl_add_u32 v65, v1, 5, v65
v_lshrrev_b32 v30, 3, v2
v_lshl_add_u32 v65, v30, 4, v65
v_bfe_u32 v30, v2, 2, 1
v_lshlrev_b32 v113, 16, v30
v_and_b32 v30, 1, v2
v_lshl_add_u32 v30, v30, 2, v1
v_lshl_add_u32 v113, v30, 4, v113
s_lshl_b32 s98, s54, 11
s_lshl2_add_u32 s101, s55, s3
s_lshl_b32 s101, s101, 7
s_add_u32 s98, s98, s101
s_add_u32 s98, s98, 524288
s_waitcnt lgkmcnt(0)
s_mul_i32 s56, s56, 1664525
s_add_u32 s56, s56, 0x3c6ef35f
v_mov_b32 v4, s56
v_not_b32 v118, v4
s_waitcnt vmcnt(9)
s_mov_b32 exec_lo, 0xf000f
s_mov_b32 exec_hi, exec_lo
buffer_store_dwordx4 v[116:119], v64, s[40:43], s62 offen
s_mov_b64 exec, -1
s_add_u32 m0, s66, 0
s_nop 0
buffer_load_dwordx4 v66, s[36:39], s64 offen lds
s_add_u32 m0, m0, 0x400
s_add_u32 s64, s64, 32768
buffer_load_dwordx4 v67, s[36:39], s64 offen lds
s_add_u32 m0, m0, 0x400
s_add_u32 s64, s64, 32768
buffer_load_dwordx4 v68, s[36:39], s64 offen lds
s_add_u32 m0, m0, 0x400
s_add_u32 s64, s64, 32768
buffer_load_dwordx4 v69, s[36:39], s64 offen lds
s_add_u32 m0, m0, 0x400
s_add_u32 s64, s64, 32768
buffer_load_dwordx4 v66, s[36:39], s64 offen lds
s_add_u32 m0, m0, 0x400
s_add_u32 s64, s64, 32768
buffer_load_dwordx4 v67, s[36:39], s64 offen lds
L_padh0:
s_cbranch_execz L_backh
s_add_u32 m0, m0, 0x400
s_add_u32 s64, s64, 32768
buffer_load_dwordx4 v68, s[36:39], s64 offen lds
s_add_u32 m0, m0, 0x400
s_add_u32 s64, s64, 32768
buffer_load_dwordx4 v69, s[36:39], s64 offen lds
ds_write2_b32 v112, v80, v81 offset0:0 offset1:1
ds_write2_b32 v112, v82, v83 offset0:2 offset1:3
ds_write2_b32 v112, v84, v85 offset0:4 offset1:5
ds_write2_b32 v112, v86, v87 offset0:6 offset1:7
ds_write_b32 v112, v88 offset:32
v_lshlrev_b32 v90, 16, v80
v_and_b32 v91, s100, v80
v_lshlrev_b32 v92, 16, v81
v_and_b32 v93, s100, v81
v_lshlrev_b32 v94, 16, v82
v_and_b32 v95, s100, v82
v_lshlrev_b32 v96, 16, v83
v_and_b32 v97, s100, v83
v_lshlrev_b32 v98, 16, v84
v_and_b32 v99, s100, v84
v_lshlrev_b32 v100, 16, v85
v_and_b32 v101, s100, v85
v_lshlrev_b32 v102, 16, v86
v_and_b32 v103, s100, v86
v_lshlrev_b32 v104, 16, v87
v_and_b32 v105, s100, v87
v_lshlrev_b32 v106, 16, v88
v_and_b32 v107, s100, v88
s_mov_b32 exec_lo, 0xf0f0f0f
s_mov_b32 exec_hi, exec_lo
ds_read_b128 v[128:131], v13 offset:11520
ds_read_b128 v[132:135], v13 offset:11584
ds_read_b128 v[136:139], v13 offset:11648
ds_read_b128 v[140:143], v13 offset:11712
ds_read_b64 v[144:145], v14 offset:11776
s_mov_b64 exec, -1
v_pk_add_f32 v[108:109], v[90:91], v[92:93]
v_pk_add_f32 v[108:109], v[108:109], v[94:95]
v_pk_add_f32 v[108:109], v[108:109], v[96:97]
v_pk_add_f32 v[108:109], v[108:109], v[98:99]
v_pk_add_f32 v[108:109], v[108:109], v[100:101]
v_pk_add_f32 v[108:109], v[108:109], v[102:103]
v_pk_add_f32 v[108:109], v[108:109], v[104:105]
v_pk_add_f32 v[108:109], v[108:109], v[106:107]
v_add_f32 v108, v108, v109
s_nop 1
v_add_f32_dpp v108, v108, v108 quad_perm:[1,0,3,2] row_mask:0xf bank_mask:0xf
s_nop 1
v_add_f32_dpp v108, v108, v108 quad_perm:[2,3,0,1] row_mask:0xf bank_mask:0xf
s_nop 1
v_add_f32_dpp v108, v108, v108 row_half_mirror row_mask:0xf bank_mask:0xf
s_nop 1
v_add_f32_dpp v108, v108, v108 row_mirror row_mask:0xf bank_mask:0xf
v_mov_b32 v109, v108
s_nop 1
v_permlane16_swap_b32 v109, v108
v_add_f32 v108, v108, v109
v_mul_f32 v108, 0x3ae38e39, v108
v_pk_add_f32 v[30:31], v[90:91], v[108:109] op_sel_hi:[1,0] neg_lo:[0,1] neg_hi:[0,1]
v_pk_mul_f32 v[110:111], v[30:31], v[30:31]
v_pk_add_f32 v[30:31], v[92:93], v[108:109] op_sel_hi:[1,0] neg_lo:[0,1] neg_hi:[0,1]
v_pk_fma_f32 v[110:111], v[30:31], v[30:31], v[110:111]
v_pk_add_f32 v[30:31], v[94:95], v[108:109] op_sel_hi:[1,0] neg_lo:[0,1] neg_hi:[0,1]
v_pk_fma_f32 v[110:111], v[30:31], v[30:31], v[110:111]
v_pk_add_f32 v[30:31], v[96:97], v[108:109] op_sel_hi:[1,0] neg_lo:[0,1] neg_hi:[0,1]
v_pk_fma_f32 v[110:111], v[30:31], v[30:31], v[110:111]
v_pk_add_f32 v[30:31], v[98:99], v[108:109] op_sel_hi:[1,0] neg_lo:[0,1] neg_hi:[0,1]
v_pk_fma_f32 v[110:111], v[30:31], v[30:31], v[110:111]
v_pk_add_f32 v[30:31], v[100:101], v[108:109] op_sel_hi:[1,0] neg_lo:[0,1] neg_hi:[0,1]
v_pk_fma_f32 v[110:111], v[30:31], v[30:31], v[110:111]
v_pk_add_f32 v[30:31], v[102:103], v[108:109] op_sel_hi:[1,0] neg_lo:[0,1] neg_hi:[0,1]
v_pk_fma_f32 v[110:111], v[30:31], v[30:31], v[110:111]
v_pk_add_f32 v[30:31], v[104:105], v[108:109] op_sel_hi:[1,0] neg_lo:[0,1] neg_hi:[0,1]
v_pk_fma_f32 v[110:111], v[30:31], v[30:31], v[110:111]
v_pk_add_f32 v[30:31], v[106:107], v[108:109] op_sel_hi:[1,0] neg_lo:[0,1] neg_hi:[0,1]
v_pk_fma_f32 v[110:111], v[30:31], v[30:31], v[110:111]
v_add_f32 v110, v110, v111
L_padh1:
s_cbranch_execz L_backh
s_nop 1
v_add_f32_dpp v110, v110, v110 quad_perm:[1,0,3,2] row_mask:0xf bank_mask:0xf
s_nop 1
v_add_f32_dpp v110, v110, v110 quad_perm:[2,3,0,1] row_mask:0xf bank_mask:0xf
s_nop 1
v_add_f32_dpp v110, v110, v110 row_half_mirror row_mask:0xf bank_mask:0xf
s_nop 1
v_add_f32_dpp v110, v110, v110 row_mirror row_mask:0xf bank_mask:0xf
v_mov_b32 v111, v110
s_nop 1
v_permlane16_swap_b32 v111, v110
v_add_f32 v110, v110, v111
v_mul_f32 v110, 0x3ae38e39, v110
v_cvt_pk_bf16_f32 v110, v110, v110
v_and_b32 v110, s100, v110
v_add_f32 v110, 0x3727c5ac, v110
v_cvt_pk_bf16_f32 v110, v110, v110
v_and_b32 v110, s100, v110
v_sqrt_f32 v110, v110
v_cvt_pk_bf16_f32 v108, v108, v108
v_and_b32 v108, s100, v108
v_cvt_pk_bf16_f32 v110, v110, v110
v_and_b32 v110, s100, v110
v_rcp_f32 v110, v110
s_mov_b32 s48, 0xaaaaaaaa
s_mov_b32 s49, s48
v_mov_b32 v30, v108
v_mov_b32 v31, v108
s_nop 1
v_permlane32_swap_b32 v30, v31
v_cndmask_b32 v114, -v30, -v31, s[48:49]
v_mov_b32 v30, v110
v_mov_b32 v31, v110
s_nop 1
v_permlane32_swap_b32 v30, v31
v_cndmask_b32 v120, v30, v31, s[48:49]
s_mov_b32 s48, 0xcccccccc
s_mov_b32 s49, s48
s_waitcnt vmcnt(8)
v_mov_b32 v78, v4
v_mov_b32 v79, v4
s_xor_b32 s65, s62, 0x20000
ds_read_b64_tr_b16 v[148:149], v8 offset:30080
ds_read_b64_tr_b16 v[150:151], v8 offset:30336
ds_read_b64_tr_b16 v[152:153], v9 offset:30080
ds_read_b64_tr_b16 v[154:155], v9 offset:30336
ds_read_b64_tr_b16 v[156:157], v8 offset:32128
ds_read_b64_tr_b16 v[158:159], v8 offset:32384
ds_read_b64_tr_b16 v[160:161], v9 offset:32128
ds_read_b64_tr_b16 v[162:163], v9 offset:32384
ds_read_b64_tr_b16 v[164:165], v8 offset:34176
ds_read_b64_tr_b16 v[166:167], v8 offset:34432
ds_read_b64_tr_b16 v[168:169], v9 offset:34176
ds_read_b64_tr_b16 v[170:171], v9 offset:34432
ds_read_b64_tr_b16 v[172:173], v8 offset:36224
ds_read_b64_tr_b16 v[174:175], v8 offset:36480
ds_read_b64_tr_b16 v[176:177], v9 offset:36224
ds_read_b64_tr_b16 v[178:179], v9 offset:36480
ds_read_b64_tr_b16 v[180:181], v10 offset:38272
ds_read_b64_tr_b16 v[182:183], v11 offset:38272
s_waitcnt lgkmcnt(14)
v_mfma_f32_16x16x32_bf16 v[48:51], v[148:151], v[128:131], 0
v_mfma_f32_16x16x32_bf16 v[52:55], v[152:155], v[128:131], 0
s_waitcnt lgkmcnt(10)
v_mfma_f32_16x16x32_bf16 v[48:51], v[156:159], v[132:135], v[48:51]
v_mfma_f32_16x16x32_bf16 v[52:55], v[160:163], v[132:135], v[52:55]
s_waitcnt lgkmcnt(6)
v_mfma_f32_16x16x32_bf16 v[48:51], v[164:167], v[136:139], v[48:51]
v_mfma_f32_16x16x32_bf16 v[52:55], v[168:171], v[136:139], v[52:55]
s_waitcnt lgkmcnt(2)
v_mfma_f32_16x16x32_bf16 v[48:51], v[172:175], v[140:143], v[48:51]
v_mfma_f32_16x16x32_bf16 v[52:55], v[176:179], v[140:143], v[52:55]
s_waitcnt lgkmcnt(0)
s_nop 3
v_mfma_f32_16x16x16_bf16 v[48:51], v[180:181], v[144:145], v[48:51]
s_nop 3
v_mfma_f32_16x16x16_bf16 v[52:55], v[182:183], v[144:145], v[52:55]
s_nop 7
v_cndmask_b32 v56, v48, v52, s[48:49]
s_nop 6
v_cndmask_b32 v57, v49, v53, s[48:49]
s_nop 5
L_padh2:
s_cbranch_execz L_backh
v_cndmask_b32 v58, v50, v54, s[48:49]
s_nop 4
v_cndmask_b32 v59, v51, v55, s[48:49]
v_fmac_f32_dpp v56, v56, v114 row_shl:4 row_mask:0xf bank_mask:0xf
v_fmac_f32_dpp v57, v57, v114 row_shl:4 row_mask:0xf bank_mask:0xf
v_fmac_f32_dpp v58, v58, v114 row_shl:4 row_mask:0xf bank_mask:0xf
v_fmac_f32_dpp v59, v59, v114 row_shl:4 row_mask:0xf bank_mask:0xf
v_pk_mul_f32 v[56:57], v[56:57], v[120:121] op_sel_hi:[1,0]
v_pk_mul_f32 v[58:59], v[58:59], v[120:121] op_sel_hi:[1,0]
v_cvt_pk_bf16_f32 v76, v56, v57
v_cvt_pk_bf16_f32 v77, v58, v59
s_mov_b32 exec_lo, 0xf000f
s_mov_b32 exec_hi, exec_lo
buffer_store_dwordx4 v[76:79], v64, s[40:43], s62 offen
s_mov_b64 exec, -1
buffer_load_dwordx4 v[32:35], v65, s[40:43], s63 offen offset:0 sc1
buffer_load_dwordx4 v[36:39], v65, s[40:43], s63 offen offset:1024 sc1
buffer_load_dwordx4 v[40:43], v65, s[40:43], s63 offen offset:2048 sc1
buffer_load_dwordx4 v[44:47], v65, s[40:43], s63 offen offset:3072 sc1
v_add_u32 v30, 0, v0
v_mul_u32_u24 v31, 0xcccd, v30
v_lshrrev_b32 v31, 18, v31
v_mul_u32_u24 v16, 5, v31
v_sub_u32 v30, v30, v16
v_mul_u32_u24 v31, 0x2400, v31
v_lshl_add_u32 v16, v30, 4, v31
v_add_u32 v30, 64, v0
v_mul_u32_u24 v31, 0xcccd, v30
v_lshrrev_b32 v31, 18, v31
v_mul_u32_u24 v17, 5, v31
v_sub_u32 v30, v30, v17
v_mul_u32_u24 v31, 0x2400, v31
v_lshl_add_u32 v17, v30, 4, v31
v_add_u32 v30, 128, v0
v_mul_u32_u24 v31, 0xcccd, v30
v_lshrrev_b32 v31, 18, v31
v_mul_u32_u24 v18, 5, v31
v_sub_u32 v30, v30, v18
v_mul_u32_u24 v31, 0x2400, v31
v_lshl_add_u32 v18, v30, 4, v31
v_add_u32 v30, 192, v0
v_mul_u32_u24 v31, 0xcccd, v30
v_lshrrev_b32 v31, 18, v31
v_mul_u32_u24 v19, 5, v31
v_sub_u32 v30, v30, v19
v_mul_u32_u24 v31, 0x2400, v31
v_lshl_add_u32 v19, v30, 4, v31
v_add_u32 v30, 256, v0
v_mul_u32_u24 v31, 0xcccd, v30
v_lshrrev_b32 v31, 18, v31
v_mul_u32_u24 v20, 5, v31
v_sub_u32 v30, v30, v20
v_mul_u32_u24 v31, 0x2400, v31
v_lshl_add_u32 v20, v30, 4, v31
v_add_u32 v30, 0x0, v0
v_mul_u32_u24 v31, 0xe39, v30
v_lshrrev_b32 v31, 16, v31
v_mul_u32_u24 v21, 18, v31
v_sub_u32 v30, v30, v21
v_mul_u32_u24 v31, 0x480, v31
v_lshl_add_u32 v21, v30, 4, v31
v_add_u32 v30, 0x40, v0
v_mul_u32_u24 v31, 0xe39, v30
v_lshrrev_b32 v31, 16, v31
v_mul_u32_u24 v22, 18, v31
v_sub_u32 v30, v30, v22
v_mul_u32_u24 v31, 0x480, v31
v_lshl_add_u32 v22, v30, 4, v31
v_add_u32 v30, 0x80, v0
v_mul_u32_u24 v31, 0xe39, v30
v_lshrrev_b32 v31, 16, v31
v_mul_u32_u24 v23, 18, v31
v_sub_u32 v30, v30, v23
v_mul_u32_u24 v31, 0x480, v31
v_lshl_add_u32 v23, v30, 4, v31
v_add_u32 v30, 0xc0, v0
v_mul_u32_u24 v31, 0xe39, v30
v_lshrrev_b32 v31, 16, v31
v_mul_u32_u24 v24, 18, v31
v_sub_u32 v30, v30, v24
v_mul_u32_u24 v31, 0x480, v31
L_padh3:
s_cbranch_execz L_backh
v_lshl_add_u32 v24, v30, 4, v31
v_add_u32 v30, 0x100, v0
v_mul_u32_u24 v31, 0xe39, v30
v_lshrrev_b32 v31, 16, v31
v_mul_u32_u24 v25, 18, v31
v_sub_u32 v30, v30, v25
v_mul_u32_u24 v31, 0x480, v31
v_lshl_add_u32 v25, v30, 4, v31
v_add_u32 v30, 0x140, v0
v_mul_u32_u24 v31, 0xe39, v30
v_lshrrev_b32 v31, 16, v31
v_mul_u32_u24 v26, 18, v31
v_sub_u32 v30, v30, v26
v_mul_u32_u24 v31, 0x480, v31
v_lshl_add_u32 v26, v30, 4, v31
v_add_u32 v30, 0x180, v0
v_mul_u32_u24 v31, 0xe39, v30
v_lshrrev_b32 v31, 16, v31
v_mul_u32_u24 v27, 18, v31
v_sub_u32 v30, v30, v27
v_mul_u32_u24 v31, 0x480, v31
v_lshl_add_u32 v27, v30, 4, v31
v_add_u32 v30, 0x1c0, v0
v_mul_u32_u24 v31, 0xe39, v30
v_lshrrev_b32 v31, 16, v31
v_mul_u32_u24 v28, 18, v31
v_sub_u32 v30, v30, v28
v_mul_u32_u24 v31, 0x480, v31
v_lshl_add_u32 v28, v30, 4, v31
v_add_u32 v30, 0x200, v0
v_mul_u32_u24 v31, 0xe39, v30
v_lshrrev_b32 v31, 16, v31
v_mul_u32_u24 v29, 18, v31
v_sub_u32 v30, v30, v29
v_mul_u32_u24 v31, 0x480, v31
v_lshl_add_u32 v29, v30, 4, v31
s_mov_b32 s48, 0xaaaaaaaa
s_mov_b32 s49, s48
s_mov_b32 s22, 0
s_mov_b32 s60, 0x3e0293ee
s_waitcnt vmcnt(4)
ds_read_b128 v[224:227], v70 offset:0
ds_read_b128 v[240:243], v70 offset:4096
ds_read_b128 v[228:231], v71 offset:0
ds_read_b128 v[244:247], v71 offset:4096
ds_read_b128 v[232:235], v72 offset:0
ds_read_b128 v[248:251], v72 offset:4096
ds_read_b128 v[236:239], v73 offset:0
ds_read_b128 v[252:255], v73 offset:4096
L_gc_1:
s_waitcnt vmcnt(3)
v_cmp_ne_u32 s[4:5], s56, v34
s_waitcnt vmcnt(2)
v_cmp_ne_u32 s[6:7], s56, v38
s_or_b64 s[50:51], s[4:5], s[6:7]
s_waitcnt vmcnt(1)
v_cmp_ne_u32 s[8:9], s56, v42
s_or_b64 s[50:51], s[50:51], s[8:9]
s_waitcnt vmcnt(0)
v_cmp_ne_u32 s[10:11], s56, v46
s_or_b64 s[50:51], s[50:51], s[10:11]
s_cmp_lg_u64 s[50:51], 0
s_cbranch_scc1 L_gr_2
v_mov_b32_dpp v34, v32 row_ror:8 row_mask:0xf bank_mask:0xf
v_mov_b32_dpp v35, v33 row_ror:8 row_mask:0xf bank_mask:0xf
v_mov_b32_dpp v38, v36 row_ror:8 row_mask:0xf bank_mask:0xf
v_mov_b32_dpp v39, v37 row_ror:8 row_mask:0xf bank_mask:0xf
v_mov_b32_dpp v42, v40 row_ror:8 row_mask:0xf bank_mask:0xf
v_mov_b32_dpp v43, v41 row_ror:8 row_mask:0xf bank_mask:0xf
v_mov_b32_dpp v46, v44 row_ror:8 row_mask:0xf bank_mask:0xf
v_mov_b32_dpp v47, v45 row_ror:8 row_mask:0xf bank_mask:0xf
s_waitcnt lgkmcnt(0)
v_mfma_f32_16x16x32_bf16 v[48:51], v[224:227], v[32:35], 0
v_mfma_f32_16x16x32_bf16 v[52:55], v[240:243], v[32:35], 0
v_mfma_f32_16x16x32_bf16 v[48:51], v[228:231], v[36:39], v[48:51]
v_mfma_f32_16x16x32_bf16 v[52:55], v[244:247], v[36:39], v[52:55]
v_mfma_f32_16x16x32_bf16 v[48:51], v[232:235], v[40:43], v[48:51]
v_mfma_f32_16x16x32_bf16 v[52:55], v[248:251], v[40:43], v[52:55]
L_padh4:
s_cbranch_execz L_backh
v_mfma_f32_16x16x32_bf16 v[48:51], v[236:239], v[44:47], v[48:51]
v_mfma_f32_16x16x32_bf16 v[52:55], v[252:255], v[44:47], v[52:55]
s_nop 7
v_cndmask_b32 v60, v48, v52, s[48:49]
s_nop 6
v_cndmask_b32 v48, v52, v48, s[48:49]
s_nop 5
v_cndmask_b32 v61, v49, v53, s[48:49]
s_nop 4
v_cndmask_b32 v49, v53, v49, s[48:49]
s_nop 3
v_cndmask_b32 v62, v50, v54, s[48:49]
s_nop 2
v_cndmask_b32 v50, v54, v50, s[48:49]
s_nop 1
v_cndmask_b32 v63, v51, v55, s[48:49]
s_nop 0
v_cndmask_b32 v51, v55, v51, s[48:49]
v_add_f32_dpp v60, v48, v60 quad_perm:[1,0,3,2] row_mask:0xf bank_mask:0xf
v_add_f32_dpp v61, v49, v61 quad_perm:[1,0,3,2] row_mask:0xf bank_mask:0xf
v_add_f32_dpp v62, v50, v62 quad_perm:[1,0,3,2] row_mask:0xf bank_mask:0xf
v_add_f32_dpp v63, v51, v63 quad_perm:[1,0,3,2] row_mask:0xf bank_mask:0xf
v_add_f32_dpp v60, v60, v60 quad_perm:[2,3,0,1] row_mask:0xf bank_mask:0xf
v_add_f32_dpp v61, v61, v61 quad_perm:[2,3,0,1] row_mask:0xf bank_mask:0xf
v_add_f32_dpp v62, v62, v62 quad_perm:[2,3,0,1] row_mask:0xf bank_mask:0xf
v_add_f32_dpp v63, v63, v63 quad_perm:[2,3,0,1] row_mask:0xf bank_mask:0xf
v_mul_f32 v60, s60, v60
v_mul_f32 v61, s60, v61
v_mul_f32 v62, s60, v62
v_mul_f32 v63, s60, v63
v_cvt_pk_bf16_f32 v56, v60, v61
v_cvt_pk_bf16_f32 v57, v62, v63
v_mov_b32 v58, v4
v_mov_b32 v59, v4
s_mov_b32 exec_lo, 0x330033
s_mov_b32 exec_hi, exec_lo
buffer_store_dwordx4 v[56:59], v113, s[40:43], s98 offen sc1
s_mov_b64 exec, -1
s_mov_b32 exec_lo, 0xf000f
s_mov_b32 exec_hi, exec_lo
buffer_store_dwordx4 v[76:79], v64, s[40:43], s65 offen sc1
s_mov_b64 exec, -1
s_mov_b32 s36, s96
s_mov_b32 s37, s97
s_mov_b32 s38, 0x400000
s_mov_b32 s39, 0x20000
s_add_u32 m0, s66, 0
s_mul_i32 s58, s3, 1327104
s_mul_i32 s59, s67, 72
s_andn2_b32 s59, s59, 15
s_add_u32 s58, s58, s59
buffer_load_dwordx4 v16, s[28:31], s58 offen lds
s_add_u32 m0, m0, 0x400
s_nop 0
buffer_load_dwordx4 v17, s[28:31], s58 offen lds
s_add_u32 m0, m0, 0x400
s_nop 0
buffer_load_dwordx4 v18, s[28:31], s58 offen lds
s_add_u32 m0, m0, 0x400
s_nop 0
buffer_load_dwordx4 v19, s[28:31], s58 offen lds
s_add_u32 m0, m0, 0x400
s_nop 0
buffer_load_dwordx4 v20, s[28:31], s58 offen lds
s_add_u32 m0, m0, 0x400
s_add_u32 s58, s58, 589824
buffer_load_dwordx4 v16, s[28:31], s58 offen lds
s_add_u32 m0, m0, 0x400
s_nop 0
buffer_load_dwordx4 v17, s[28:31], s58 offen lds
s_add_u32 m0, m0, 0x400
s_nop 0
buffer_load_dwordx4 v18, s[28:31], s58 offen lds
s_add_u32 m0, m0, 0x400
s_nop 0
buffer_load_dwordx4 v19, s[28:31], s58 offen lds
s_add_u32 m0, m0, 0x400
s_nop 0
buffer_load_dwordx4 v20, s[28:31], s58 offen lds
L_padh5:
s_cbranch_execz L_backh
s_add_u32 m0, m0, 0x400
s_add_u32 s58, s58, 589824
buffer_load_dwordx4 v16, s[28:31], s58 offen lds
s_add_u32 m0, m0, 0x400
s_mov_b64 exec, 0xffff
buffer_load_dwordx4 v17, s[28:31], s58 offen lds
s_mov_b64 exec, -1
s_lshl_b32 s58, s52, 11
s_add_u32 s58, s58, 32768
v_lshlrev_b32 v36, 7, v2
s_mov_b32 s22, 24
buffer_load_dwordx4 v[32:35], v36, s[40:43], s58 offen sc1
L_gc_8:
s_waitcnt vmcnt(0)
v_cmp_ne_u32 s[4:5], s56, v34
s_cmp_lg_u64 s[4:5], 0
s_cbranch_scc1 L_gr_9
L_gb_10:
s_add_u32 m0, s66, 11520
s_mul_i32 s58, s67, 41472
s_mul_i32 s59, s3, 288
s_add_u32 s58, s58, s59
buffer_load_dwordx4 v21, s[32:35], s58 offen lds
s_add_u32 m0, m0, 0x400
s_nop 0
buffer_load_dwordx4 v22, s[32:35], s58 offen lds
s_add_u32 m0, m0, 0x400
s_nop 0
buffer_load_dwordx4 v23, s[32:35], s58 offen lds
s_add_u32 m0, m0, 0x400
s_nop 0
buffer_load_dwordx4 v24, s[32:35], s58 offen lds
s_add_u32 m0, m0, 0x400
s_nop 0
buffer_load_dwordx4 v25, s[32:35], s58 offen lds
s_add_u32 m0, m0, 0x400
s_nop 0
buffer_load_dwordx4 v26, s[32:35], s58 offen lds
s_add_u32 m0, m0, 0x400
s_nop 0
buffer_load_dwordx4 v27, s[32:35], s58 offen lds
s_add_u32 m0, m0, 0x400
s_nop 0
buffer_load_dwordx4 v28, s[32:35], s58 offen lds
s_add_u32 m0, m0, 0x400
s_nop 0
buffer_load_dwordx4 v29, s[32:35], s58 offen lds
s_add_u32 m0, m0, 0x400
s_add_u32 s58, s58, 36864
buffer_load_dwordx4 v21, s[32:35], s58 offen lds
s_add_u32 m0, m0, 0x400
s_mov_b64 exec, 0xff
buffer_load_dwordx4 v22, s[32:35], s58 offen lds
s_mov_b64 exec, -1
s_add_u32 m0, s66, 21888
s_lshl_b32 s58, s3, 20
s_lshl2_add_u32 s59, s54, s55
s_lshl_b32 s59, s59, 6
s_add_u32 s58, s58, s59
buffer_load_dwordx4 v6, s[36:39], s58 offen lds
s_add_u32 m0, m0, 0x400
s_add_u32 s58, s58, 131072
buffer_load_dwordx4 v6, s[36:39], s58 offen lds
s_add_u32 m0, m0, 0x400
s_add_u32 s58, s58, 131072
buffer_load_dwordx4 v6, s[36:39], s58 offen lds
s_add_u32 m0, m0, 0x400
s_add_u32 s58, s58, 131072
buffer_load_dwordx4 v6, s[36:39], s58 offen lds
s_add_u32 m0, m0, 0x400
s_add_u32 s58, s58, 131072
buffer_load_dwordx4 v6, s[36:39], s58 offen lds
s_add_u32 m0, m0, 0x400
s_add_u32 s58, s58, 131072
buffer_load_dwordx4 v6, s[36:39], s58 offen lds
s_add_u32 m0, m0, 0x400
L_padh6:
s_cbranch_execz L_backh
s_add_u32 s58, s58, 131072
buffer_load_dwordx4 v6, s[36:39], s58 offen lds
s_add_u32 m0, m0, 0x400
s_add_u32 s58, s58, 131072
buffer_load_dwordx4 v6, s[36:39], s58 offen lds
s_add_u32 m0, s66, 30080
s_lshl2_add_u32 s58, s54, s55
s_mul_i32 s58, s58, 36864
s_mul_i32 s59, s3, 288
s_add_u32 s58, s58, s59
buffer_load_dwordx4 v21, s[44:47], s58 offen lds
s_add_u32 m0, m0, 0x400
s_nop 0
buffer_load_dwordx4 v22, s[44:47], s58 offen lds
s_add_u32 m0, m0, 0x400
s_nop 0
buffer_load_dwordx4 v23, s[44:47], s58 offen lds
s_add_u32 m0, m0, 0x400
s_nop 0
buffer_load_dwordx4 v24, s[44:47], s58 offen lds
s_add_u32 m0, m0, 0x400
s_nop 0
buffer_load_dwordx4 v25, s[44:47], s58 offen lds
s_add_u32 m0, m0, 0x400
s_nop 0
buffer_load_dwordx4 v26, s[44:47], s58 offen lds
s_add_u32 m0, m0, 0x400
s_nop 0
buffer_load_dwordx4 v27, s[44:47], s58 offen lds
s_add_u32 m0, m0, 0x400
s_nop 0
buffer_load_dwordx4 v28, s[44:47], s58 offen lds
s_add_u32 m0, m0, 0x400
s_nop 0
buffer_load_dwordx4 v29, s[44:47], s58 offen lds
s_mul_i32 s101, s3, 288
s_add_u32 s101, s101, 157184
v_add_u32 v12, s101, v12
v_add_u32 v15, s101, v15
v_add_u32 v5, 157184, v5
v_pk_add_f32 v[90:91], v[90:91], v[108:109] op_sel_hi:[1,0] neg_lo:[0,1] neg_hi:[0,1]
v_cvt_pk_bf16_f32 v80, v90, v91
v_pk_add_f32 v[92:93], v[92:93], v[108:109] op_sel_hi:[1,0] neg_lo:[0,1] neg_hi:[0,1]
v_cvt_pk_bf16_f32 v81, v92, v93
v_pk_add_f32 v[94:95], v[94:95], v[108:109] op_sel_hi:[1,0] neg_lo:[0,1] neg_hi:[0,1]
v_cvt_pk_bf16_f32 v82, v94, v95
v_pk_add_f32 v[96:97], v[96:97], v[108:109] op_sel_hi:[1,0] neg_lo:[0,1] neg_hi:[0,1]
v_cvt_pk_bf16_f32 v83, v96, v97
v_pk_add_f32 v[98:99], v[98:99], v[108:109] op_sel_hi:[1,0] neg_lo:[0,1] neg_hi:[0,1]
v_cvt_pk_bf16_f32 v84, v98, v99
v_pk_add_f32 v[100:101], v[100:101], v[108:109] op_sel_hi:[1,0] neg_lo:[0,1] neg_hi:[0,1]
v_cvt_pk_bf16_f32 v85, v100, v101
v_pk_add_f32 v[102:103], v[102:103], v[108:109] op_sel_hi:[1,0] neg_lo:[0,1] neg_hi:[0,1]
v_cvt_pk_bf16_f32 v86, v102, v103
v_pk_add_f32 v[104:105], v[104:105], v[108:109] op_sel_hi:[1,0] neg_lo:[0,1] neg_hi:[0,1]
v_cvt_pk_bf16_f32 v87, v104, v105
v_pk_add_f32 v[106:107], v[106:107], v[108:109] op_sel_hi:[1,0] neg_lo:[0,1] neg_hi:[0,1]
v_cvt_pk_bf16_f32 v88, v106, v107
v_lshlrev_b32 v90, 16, v80
v_and_b32 v91, s100, v80
v_lshlrev_b32 v92, 16, v81
v_and_b32 v93, s100, v81
v_lshlrev_b32 v94, 16, v82
v_and_b32 v95, s100, v82
v_lshlrev_b32 v96, 16, v83
v_and_b32 v97, s100, v83
v_lshlrev_b32 v98, 16, v84
v_and_b32 v99, s100, v84
v_lshlrev_b32 v100, 16, v85
v_and_b32 v101, s100, v85
v_lshlrev_b32 v102, 16, v86
v_and_b32 v103, s100, v86
v_lshlrev_b32 v104, 16, v87
v_and_b32 v105, s100, v87
v_lshlrev_b32 v106, 16, v88
v_and_b32 v107, s100, v88
v_pk_mul_f32 v[90:91], v[90:91], v[110:111] op_sel_hi:[1,0]
v_cvt_pk_bf16_f32 v80, v90, v91
v_pk_mul_f32 v[92:93], v[92:93], v[110:111] op_sel_hi:[1,0]
L_padh7:
s_cbranch_execz L_backh
v_cvt_pk_bf16_f32 v81, v92, v93
ds_write2_b32 v5, v80, v81 offset0:0 offset1:1
v_pk_mul_f32 v[94:95], v[94:95], v[110:111] op_sel_hi:[1,0]
v_cvt_pk_bf16_f32 v82, v94, v95
v_pk_mul_f32 v[96:97], v[96:97], v[110:111] op_sel_hi:[1,0]
v_cvt_pk_bf16_f32 v83, v96, v97
ds_write2_b32 v5, v82, v83 offset0:2 offset1:3
v_pk_mul_f32 v[98:99], v[98:99], v[110:111] op_sel_hi:[1,0]
v_cvt_pk_bf16_f32 v84, v98, v99
v_pk_mul_f32 v[100:101], v[100:101], v[110:111] op_sel_hi:[1,0]
v_cvt_pk_bf16_f32 v85, v100, v101
ds_write2_b32 v5, v84, v85 offset0:4 offset1:5
v_pk_mul_f32 v[102:103], v[102:103], v[110:111] op_sel_hi:[1,0]
v_cvt_pk_bf16_f32 v86, v102, v103
v_pk_mul_f32 v[104:105], v[104:105], v[110:111] op_sel_hi:[1,0]
v_cvt_pk_bf16_f32 v87, v104, v105
ds_write2_b32 v5, v86, v87 offset0:6 offset1:7
v_pk_mul_f32 v[106:107], v[106:107], v[110:111] op_sel_hi:[1,0]
v_cvt_pk_bf16_f32 v88, v106, v107
ds_write_b32 v5, v88 offset:32
v_bfe_u32 v30, v0, 2, 2
v_and_b32 v31, 3, v0
s_and_b32 s58, s67, 1
s_lshl3_add_u32 s58, s58, s66
v_lshl_add_u32 v24, v1, 3, v30
v_mul_u32_u24 v24, 80, v24
v_add_u32 v17, s58, v24
v_lshl_add_u32 v16, v31, 3, v17
v_lshl_add_u32 v24, v1, 2, v30
v_mul_u32_u24 v25, 80, v24
v_add_u32 v19, s58, v25
v_lshl_add_u32 v18, v31, 3, v19
v_mul_u32_u24 v24, 0x120, v24
v_lshl_add_u32 v24, v31, 3, v24
v_add_u32 v20, s66, v24
v_mul_u32_u24 v24, 0x120, v30
v_lshl_add_u32 v24, v31, 3, v24
v_add_u32 v21, s66, v24
v_and_b32 v24, 1, v2
v_lshlrev_b32 v24, 6, v24
v_lshl_add_u32 v24, v1, 4, v24
v_bfe_u32 v25, v2, 1, 2
v_mul_u32_u24 v26, 0x180, v25
v_add_u32 v23, v24, v26
v_add_u32 v23, 159488, v23
s_mul_i32 s58, s3, 384
s_add_u32 s58, s58, 159488
v_add_u32 v22, s58, v24
v_lshlrev_b32 v25, 8, v25
v_and_b32 v26, 1, v2
v_lshl_add_u32 v25, v26, 7, v25
v_lshl_add_u32 v25, v1, 4, v25
v_add_u32 v25, 161024, v25
v_bfe_u32 v26, v2, 2, 1
v_lshl_add_u32 v24, v26, 7, v24
s_lshl_b32 s58, s3, 8
s_add_u32 s58, s58, 161024
v_add_u32 v24, s58, v24
v_and_b32 v26, 7, v2
v_lshlrev_b32 v28, 4, v26
v_lshlrev_b32 v26, 9, v26
v_lshl_add_u32 v26, v1, 5, v26
v_lshrrev_b32 v29, 3, v2
v_lshl_add_u32 v26, v29, 4, v26
s_lshl_b32 s59, s54, 14
s_lshl_b32 s60, s3, 12
s_add_u32 s59, s59, s60
s_add_u32 s59, s59, 1048576
v_lshl_add_u32 v27, v29, 18, v28
v_lshl_add_u32 v27, v1, 16, v27
v_add_u32 v28, 0x80000, v28
s_lshl_b32 s60, s3, 14
s_lshl_b32 s61, s67, 7
s_add_u32 s60, s60, s61
s_add_u32 s60, s60, 2097152
s_waitcnt vmcnt(28)
L_padh8:
s_cbranch_execz L_backh
ds_read_b128 v[140:143], v12 offset:0
ds_read_b64_tr_b16 v[128:129], v16 offset:0
ds_read_b64_tr_b16 v[130:131], v16 offset:320
ds_read_b64_tr_b16 v[132:133], v16 offset:32
ds_read_b64_tr_b16 v[134:135], v16 offset:352
ds_read_b64_tr_b16 v[136:137], v17 offset:64
ds_read_b64_tr_b16 v[138:139], v17 offset:384
ds_read_b128 v[156:159], v12 offset:64
ds_read_b64_tr_b16 v[144:145], v16 offset:2560
ds_read_b64_tr_b16 v[146:147], v16 offset:2880
ds_read_b64_tr_b16 v[148:149], v16 offset:2592
ds_read_b64_tr_b16 v[150:151], v16 offset:2912
ds_read_b64_tr_b16 v[152:153], v17 offset:2624
ds_read_b64_tr_b16 v[154:155], v17 offset:2944
ds_read_b128 v[172:175], v12 offset:128
ds_read_b64_tr_b16 v[160:161], v16 offset:5120
ds_read_b64_tr_b16 v[162:163], v16 offset:5440
ds_read_b64_tr_b16 v[164:165], v16 offset:5152
ds_read_b64_tr_b16 v[166:167], v16 offset:5472
ds_read_b64_tr_b16 v[168:169], v17 offset:5184
ds_read_b64_tr_b16 v[170:171], v17 offset:5504
ds_read_b128 v[188:191], v12 offset:192
ds_read_b64_tr_b16 v[176:177], v16 offset:7680
ds_read_b64_tr_b16 v[178:179], v16 offset:8000
ds_read_b64_tr_b16 v[180:181], v16 offset:7712
ds_read_b64_tr_b16 v[182:183], v16 offset:8032
ds_read_b64_tr_b16 v[184:185], v17 offset:7744
ds_read_b64_tr_b16 v[186:187], v17 offset:8064
ds_read_b64 v[198:199], v15 offset:256
ds_read_b64_tr_b16 v[192:193], v18 offset:10240
ds_read_b64_tr_b16 v[194:195], v18 offset:10272
ds_read_b64_tr_b16 v[196:197], v19 offset:10304
s_waitcnt lgkmcnt(15)
v_mfma_f32_16x16x32_bf16 v[48:51], v[128:131], v[140:143], 0
v_mfma_f32_16x16x32_bf16 v[52:55], v[132:135], v[140:143], 0
v_mfma_f32_16x16x32_bf16 v[56:59], v[136:139], v[140:143], 0
s_waitcnt lgkmcnt(15)
v_mfma_f32_16x16x32_bf16 v[48:51], v[144:147], v[156:159], v[48:51]
v_mfma_f32_16x16x32_bf16 v[52:55], v[148:151], v[156:159], v[52:55]
v_mfma_f32_16x16x32_bf16 v[56:59], v[152:155], v[156:159], v[56:59]
s_waitcnt lgkmcnt(11)
v_mfma_f32_16x16x32_bf16 v[48:51], v[160:163], v[172:175], v[48:51]
v_mfma_f32_16x16x32_bf16 v[52:55], v[164:167], v[172:175], v[52:55]
v_mfma_f32_16x16x32_bf16 v[56:59], v[168:171], v[172:175], v[56:59]
s_waitcnt lgkmcnt(4)
v_mfma_f32_16x16x32_bf16 v[48:51], v[176:179], v[188:191], v[48:51]
v_mfma_f32_16x16x32_bf16 v[52:55], v[180:183], v[188:191], v[52:55]
v_mfma_f32_16x16x32_bf16 v[56:59], v[184:187], v[188:191], v[56:59]
s_waitcnt lgkmcnt(0)
s_nop 2
v_mfma_f32_16x16x16_bf16 v[48:51], v[192:193], v[198:199], v[48:51]
s_nop 2
v_mfma_f32_16x16x16_bf16 v[52:55], v[194:195], v[198:199], v[52:55]
s_nop 2
v_mfma_f32_16x16x16_bf16 v[56:59], v[196:197], v[198:199], v[56:59]
s_mov_b32 exec_lo, 0x30003
s_mov_b32 exec_hi, exec_lo
s_nop 3
ds_write_b128 v22, v[48:51] offset:0
s_nop 3
ds_write_b128 v22, v[52:55] offset:128
s_nop 3
ds_write_b128 v22, v[56:59] offset:256
s_mov_b64 exec, -1
s_waitcnt lgkmcnt(0)
s_barrier
ds_read_b128 v[48:51], v23 offset:0
ds_read_b128 v[52:55], v23 offset:128
ds_read_b128 v[56:59], v23 offset:256
s_waitcnt lgkmcnt(0)
v_add_f32_dpp v48, v48, v48 quad_perm:[2,3,0,1] row_mask:0xf bank_mask:0xf
v_add_f32_dpp v49, v49, v49 quad_perm:[2,3,0,1] row_mask:0xf bank_mask:0xf
L_padh9:
s_cbranch_execz L_backh
v_add_f32_dpp v50, v50, v50 quad_perm:[2,3,0,1] row_mask:0xf bank_mask:0xf
v_add_f32_dpp v51, v51, v51 quad_perm:[2,3,0,1] row_mask:0xf bank_mask:0xf
v_add_f32_dpp v52, v52, v52 quad_perm:[2,3,0,1] row_mask:0xf bank_mask:0xf
v_add_f32_dpp v53, v53, v53 quad_perm:[2,3,0,1] row_mask:0xf bank_mask:0xf
v_add_f32_dpp v54, v54, v54 quad_perm:[2,3,0,1] row_mask:0xf bank_mask:0xf
v_add_f32_dpp v55, v55, v55 quad_perm:[2,3,0,1] row_mask:0xf bank_mask:0xf
v_add_f32_dpp v56, v56, v56 quad_perm:[2,3,0,1] row_mask:0xf bank_mask:0xf
v_add_f32_dpp v57, v57, v57 quad_perm:[2,3,0,1] row_mask:0xf bank_mask:0xf
v_add_f32_dpp v58, v58, v58 quad_perm:[2,3,0,1] row_mask:0xf bank_mask:0xf
v_add_f32_dpp v59, v59, v59 quad_perm:[2,3,0,1] row_mask:0xf bank_mask:0xf
v_add_f32_dpp v48, v48, v48 row_ror:4 row_mask:0xf bank_mask:0xf
v_add_f32_dpp v49, v49, v49 row_ror:4 row_mask:0xf bank_mask:0xf
v_add_f32_dpp v50, v50, v50 row_ror:4 row_mask:0xf bank_mask:0xf
v_add_f32_dpp v51, v51, v51 row_ror:4 row_mask:0xf bank_mask:0xf
v_add_f32_dpp v52, v52, v52 row_ror:4 row_mask:0xf bank_mask:0xf
v_add_f32_dpp v53, v53, v53 row_ror:4 row_mask:0xf bank_mask:0xf
v_add_f32_dpp v54, v54, v54 row_ror:4 row_mask:0xf bank_mask:0xf
v_add_f32_dpp v55, v55, v55 row_ror:4 row_mask:0xf bank_mask:0xf
v_add_f32_dpp v56, v56, v56 row_ror:4 row_mask:0xf bank_mask:0xf
v_add_f32_dpp v57, v57, v57 row_ror:4 row_mask:0xf bank_mask:0xf
v_add_f32_dpp v58, v58, v58 row_ror:4 row_mask:0xf bank_mask:0xf
v_add_f32_dpp v59, v59, v59 row_ror:4 row_mask:0xf bank_mask:0xf
v_cvt_pk_bf16_f32 v32, v48, v49
v_cvt_pk_bf16_f32 v33, v50, v51
v_cvt_pk_bf16_f32 v34, v52, v53
v_cvt_pk_bf16_f32 v35, v54, v55
v_cvt_pk_bf16_f32 v36, v56, v57
v_cvt_pk_bf16_f32 v37, v58, v59
v_lshlrev_b32 v48, 16, v32
v_and_b32 v49, s100, v32
v_lshlrev_b32 v50, 16, v33
v_and_b32 v51, s100, v33
v_lshlrev_b32 v52, 16, v34
v_and_b32 v53, s100, v34
v_lshlrev_b32 v54, 16, v35
v_and_b32 v55, s100, v35
v_lshlrev_b32 v56, 16, v36
v_and_b32 v57, s100, v36
v_lshlrev_b32 v58, 16, v37
v_and_b32 v59, s100, v37
s_mov_b32 s101, 0xbfb8aa3b
v_mul_f32 v32, s101, v48
v_mul_f32 v33, s101, v49
v_mul_f32 v34, s101, v50
v_mul_f32 v35, s101, v51
v_mul_f32 v36, s101, v52
v_mul_f32 v37, s101, v53
v_mul_f32 v38, s101, v54
v_mul_f32 v39, s101, v55
v_mul_f32 v40, s101, v56
v_mul_f32 v41, s101, v57
v_mul_f32 v42, s101, v58
v_mul_f32 v43, s101, v59
v_exp_f32 v32, v32
v_exp_f32 v33, v33
v_exp_f32 v34, v34
v_exp_f32 v35, v35
v_exp_f32 v36, v36
v_exp_f32 v37, v37
v_exp_f32 v38, v38
v_exp_f32 v39, v39
v_exp_f32 v40, v40
v_exp_f32 v41, v41
v_exp_f32 v42, v42
v_exp_f32 v43, v43
v_add_f32 v32, 1.0, v32
v_add_f32 v33, 1.0, v33
v_add_f32 v34, 1.0, v34
v_add_f32 v35, 1.0, v35
v_add_f32 v36, 1.0, v36
v_add_f32 v37, 1.0, v37
v_add_f32 v38, 1.0, v38
v_add_f32 v39, 1.0, v39
v_add_f32 v40, 1.0, v40
v_add_f32 v41, 1.0, v41
v_add_f32 v42, 1.0, v42
v_add_f32 v43, 1.0, v43
v_rcp_f32 v32, v32
v_rcp_f32 v33, v33
v_rcp_f32 v34, v34
v_rcp_f32 v35, v35
v_rcp_f32 v36, v36
v_rcp_f32 v37, v37
v_rcp_f32 v38, v38
v_rcp_f32 v39, v39
v_rcp_f32 v40, v40
v_rcp_f32 v41, v41
v_rcp_f32 v42, v42
v_rcp_f32 v43, v43
v_mul_f32 v48, v48, v32
v_mul_f32 v49, v49, v33
v_mul_f32 v50, v50, v34
v_mul_f32 v51, v51, v35
v_mul_f32 v52, v52, v36
v_mul_f32 v53, v53, v37
v_mul_f32 v54, v54, v38
v_mul_f32 v55, v55, v39
L_padh10:
s_cbranch_execz L_backh
v_mul_f32 v56, v56, v40
v_mul_f32 v57, v57, v41
v_mul_f32 v58, v58, v42
v_mul_f32 v59, v59, v43
v_cvt_pk_bf16_f32 v100, v48, v49
v_cvt_pk_bf16_f32 v101, v50, v51
v_cvt_pk_bf16_f32 v102, v52, v53
v_cvt_pk_bf16_f32 v103, v54, v55
v_cvt_pk_bf16_f32 v104, v56, v57
v_cvt_pk_bf16_f32 v105, v58, v59
s_mov_b32 s48, 0xffff
s_mov_b32 s49, 0x0
v_cndmask_b32 v104, 0, v104, s[48:49]
v_cndmask_b32 v105, 0, v105, s[48:49]
s_waitcnt vmcnt(17)
ds_read_b64_tr_b16 v[128:129], v20 offset:11520
ds_read_b64_tr_b16 v[130:131], v20 offset:16128
ds_read_b64_tr_b16 v[132:133], v21 offset:20736
ds_read_b64_tr_b16 v[134:135], v20 offset:11552
ds_read_b64_tr_b16 v[136:137], v20 offset:16160
ds_read_b64_tr_b16 v[138:139], v21 offset:20768
ds_read_b64_tr_b16 v[140:141], v20 offset:11584
ds_read_b64_tr_b16 v[142:143], v20 offset:16192
ds_read_b64_tr_b16 v[144:145], v21 offset:20800
ds_read_b64_tr_b16 v[146:147], v20 offset:11616
ds_read_b64_tr_b16 v[148:149], v20 offset:16224
ds_read_b64_tr_b16 v[150:151], v21 offset:20832
ds_read_b64_tr_b16 v[152:153], v20 offset:11648
ds_read_b64_tr_b16 v[154:155], v20 offset:16256
ds_read_b64_tr_b16 v[156:157], v21 offset:20864
ds_read_b64_tr_b16 v[158:159], v20 offset:11680
ds_read_b64_tr_b16 v[160:161], v20 offset:16288
ds_read_b64_tr_b16 v[162:163], v21 offset:20896
ds_read_b64_tr_b16 v[164:165], v20 offset:11712
ds_read_b64_tr_b16 v[166:167], v20 offset:16320
ds_read_b64_tr_b16 v[168:169], v21 offset:20928
ds_read_b64_tr_b16 v[170:171], v20 offset:11744
ds_read_b64_tr_b16 v[172:173], v20 offset:16352
ds_read_b64_tr_b16 v[174:175], v21 offset:20960
ds_read_b64_tr_b16 v[176:177], v20 offset:11776
ds_read_b64_tr_b16 v[178:179], v20 offset:16384
ds_read_b64_tr_b16 v[180:181], v21 offset:20992
s_waitcnt lgkmcnt(15)
v_mfma_f32_16x16x32_bf16 v[64:67], v[100:103], v[128:131], 0
s_waitcnt lgkmcnt(15)
v_mfma_f32_16x16x32_bf16 v[68:71], v[100:103], v[134:137], 0
s_waitcnt lgkmcnt(15)
v_mfma_f32_16x16x32_bf16 v[72:75], v[100:103], v[140:143], 0
s_waitcnt lgkmcnt(15)
v_mfma_f32_16x16x32_bf16 v[76:79], v[100:103], v[146:149], 0
s_waitcnt lgkmcnt(12)
v_mfma_f32_16x16x32_bf16 v[80:83], v[100:103], v[152:155], 0
s_waitcnt lgkmcnt(9)
v_mfma_f32_16x16x32_bf16 v[84:87], v[100:103], v[158:161], 0
s_waitcnt lgkmcnt(6)
v_mfma_f32_16x16x32_bf16 v[88:91], v[100:103], v[164:167], 0
s_waitcnt lgkmcnt(3)
v_mfma_f32_16x16x32_bf16 v[92:95], v[100:103], v[170:173], 0
s_waitcnt lgkmcnt(0)
v_mfma_f32_16x16x32_bf16 v[96:99], v[100:103], v[176:179], 0
v_mfma_f32_16x16x16_bf16 v[64:67], v[104:105], v[132:133], v[64:67]
v_mfma_f32_16x16x16_bf16 v[68:71], v[104:105], v[138:139], v[68:71]
v_mfma_f32_16x16x16_bf16 v[72:75], v[104:105], v[144:145], v[72:75]
v_mfma_f32_16x16x16_bf16 v[76:79], v[104:105], v[150:151], v[76:79]
v_mfma_f32_16x16x16_bf16 v[80:83], v[104:105], v[156:157], v[80:83]
v_mfma_f32_16x16x16_bf16 v[84:87], v[104:105], v[162:163], v[84:87]
v_mfma_f32_16x16x16_bf16 v[88:91], v[104:105], v[168:169], v[88:91]
v_mfma_f32_16x16x16_bf16 v[92:95], v[104:105], v[174:175], v[92:95]
v_mfma_f32_16x16x16_bf16 v[96:99], v[104:105], v[180:181], v[96:99]
s_waitcnt vmcnt(0)
buffer_load_dwordx4 v[32:35], v26, s[40:43], s59 offen offset:0 sc1
buffer_load_dwordx4 v[36:39], v26, s[40:43], s59 offen offset:128 sc1
L_padh11:
s_cbranch_execz L_backh
buffer_load_dwordx4 v[40:43], v26, s[40:43], s59 offen offset:256 sc1
buffer_load_dwordx4 v[44:47], v26, s[40:43], s59 offen offset:384 sc1
ds_read_b64_tr_b16 v[220:221], v8 offset:21888
ds_read_b64_tr_b16 v[222:223], v8 offset:22144
ds_read_b64_tr_b16 v[224:225], v9 offset:21888
ds_read_b64_tr_b16 v[226:227], v9 offset:22144
ds_read_b64_tr_b16 v[228:229], v8 offset:23936
ds_read_b64_tr_b16 v[230:231], v8 offset:24192
ds_read_b64_tr_b16 v[232:233], v9 offset:23936
ds_read_b64_tr_b16 v[234:235], v9 offset:24192
ds_read_b64_tr_b16 v[236:237], v8 offset:25984
ds_read_b64_tr_b16 v[238:239], v8 offset:26240
ds_read_b64_tr_b16 v[240:241], v9 offset:25984
ds_read_b64_tr_b16 v[242:243], v9 offset:26240
ds_read_b64_tr_b16 v[244:245], v8 offset:28032
ds_read_b64_tr_b16 v[246:247], v8 offset:28288
ds_read_b64_tr_b16 v[248:249], v9 offset:28032
ds_read_b64_tr_b16 v[250:251], v9 offset:28288
ds_read_b64_tr_b16 v[184:185], v20 offset:30080
ds_read_b64_tr_b16 v[186:187], v20 offset:34688
ds_read_b64_tr_b16 v[188:189], v20 offset:30112
ds_read_b64_tr_b16 v[190:191], v20 offset:34720
ds_read_b64_tr_b16 v[192:193], v20 offset:30144
ds_read_b64_tr_b16 v[194:195], v20 offset:34752
ds_read_b64_tr_b16 v[196:197], v20 offset:30176
ds_read_b64_tr_b16 v[198:199], v20 offset:34784
ds_read_b64_tr_b16 v[200:201], v20 offset:30208
ds_read_b64_tr_b16 v[202:203], v20 offset:34816
ds_read_b64_tr_b16 v[204:205], v20 offset:30240
ds_read_b64_tr_b16 v[206:207], v20 offset:34848
ds_read_b64_tr_b16 v[208:209], v20 offset:30272
ds_read_b64_tr_b16 v[210:211], v20 offset:34880
ds_read_b64_tr_b16 v[212:213], v20 offset:30304
ds_read_b64_tr_b16 v[214:215], v20 offset:34912
ds_read_b64_tr_b16 v[216:217], v20 offset:30336
ds_read_b64_tr_b16 v[218:219], v20 offset:34944
s_mov_b32 s48, 0xaaaaaaaa
s_mov_b32 s49, s48
L_gc_12:
s_waitcnt vmcnt(3)
v_cmp_ne_u32 s[4:5], s56, v34
s_waitcnt vmcnt(2)
v_cmp_ne_u32 s[6:7], s56, v38
s_or_b64 s[50:51], s[4:5], s[6:7]
s_waitcnt vmcnt(1)
v_cmp_ne_u32 s[8:9], s56, v42
s_or_b64 s[50:51], s[50:51], s[8:9]
s_waitcnt vmcnt(0)
v_cmp_ne_u32 s[10:11], s56, v46
s_or_b64 s[50:51], s[50:51], s[10:11]
s_cmp_lg_u64 s[50:51], 0
s_cbranch_scc1 L_gr_13
v_mov_b32 v60, v35
v_mov_b32_dpp v61, v35 row_ror:8 row_mask:0xf bank_mask:0xf
v_mov_b32_dpp v34, v32 row_ror:8 row_mask:0xf bank_mask:0xf
v_mov_b32_dpp v35, v33 row_ror:8 row_mask:0xf bank_mask:0xf
v_mov_b32_dpp v38, v36 row_ror:8 row_mask:0xf bank_mask:0xf
v_mov_b32_dpp v39, v37 row_ror:8 row_mask:0xf bank_mask:0xf
v_mov_b32_dpp v42, v40 row_ror:8 row_mask:0xf bank_mask:0xf
v_mov_b32_dpp v43, v41 row_ror:8 row_mask:0xf bank_mask:0xf
v_mov_b32_dpp v46, v44 row_ror:8 row_mask:0xf bank_mask:0xf
v_mov_b32_dpp v47, v45 row_ror:8 row_mask:0xf bank_mask:0xf
s_waitcnt lgkmcnt(0)
v_mfma_f32_16x16x32_bf16 v[48:51], v[220:223], v[32:35], 0
v_mfma_f32_16x16x32_bf16 v[52:55], v[224:227], v[32:35], 0
v_mfma_f32_16x16x32_bf16 v[48:51], v[228:231], v[36:39], v[48:51]
v_mfma_f32_16x16x32_bf16 v[52:55], v[232:235], v[36:39], v[52:55]
v_mfma_f32_16x16x32_bf16 v[48:51], v[236:239], v[40:43], v[48:51]
v_mfma_f32_16x16x32_bf16 v[52:55], v[240:243], v[40:43], v[52:55]
v_mfma_f32_16x16x32_bf16 v[48:51], v[244:247], v[44:47], v[48:51]
L_padh12:
s_cbranch_execz L_backh
v_mfma_f32_16x16x32_bf16 v[52:55], v[248:251], v[44:47], v[52:55]
v_max_f32_dpp v62, v60, v60 quad_perm:[1,0,3,2] row_mask:0xf bank_mask:0xf
s_nop 1
v_max_f32_dpp v62, v62, v62 quad_perm:[2,3,0,1] row_mask:0xf bank_mask:0xf
v_sub_f32 v60, v60, v62
v_exp_f32 v60, v60
s_nop 0
v_mul_f32 v61, v60, v61
s_nop 1
v_add_f32_dpp v61, v61, v61 quad_perm:[1,0,3,2] row_mask:0xf bank_mask:0xf
s_nop 1
v_add_f32_dpp v61, v61, v61 quad_perm:[2,3,0,1] row_mask:0xf bank_mask:0xf
v_rcp_f32 v61, v61
s_nop 0
v_mul_f32 v60, v60, v61
v_mul_f32 v48, v48, v60
v_mul_f32 v49, v49, v60
v_mul_f32 v50, v50, v60
v_mul_f32 v51, v51, v60
v_mul_f32 v52, v52, v60
v_mul_f32 v53, v53, v60
v_mul_f32 v54, v54, v60
v_mul_f32 v55, v55, v60
v_cndmask_b32 v56, v48, v52, s[48:49]
v_cndmask_b32 v48, v52, v48, s[48:49]
v_cndmask_b32 v57, v49, v53, s[48:49]
v_cndmask_b32 v49, v53, v49, s[48:49]
v_cndmask_b32 v58, v50, v54, s[48:49]
v_cndmask_b32 v50, v54, v50, s[48:49]
v_cndmask_b32 v59, v51, v55, s[48:49]
v_cndmask_b32 v51, v55, v51, s[48:49]
v_add_f32_dpp v56, v48, v56 quad_perm:[1,0,3,2] row_mask:0xf bank_mask:0xf
v_add_f32_dpp v57, v49, v57 quad_perm:[1,0,3,2] row_mask:0xf bank_mask:0xf
v_add_f32_dpp v58, v50, v58 quad_perm:[1,0,3,2] row_mask:0xf bank_mask:0xf
v_add_f32_dpp v59, v51, v59 quad_perm:[1,0,3,2] row_mask:0xf bank_mask:0xf
v_add_f32_dpp v56, v56, v56 quad_perm:[2,3,0,1] row_mask:0xf bank_mask:0xf
v_add_f32_dpp v57, v57, v57 quad_perm:[2,3,0,1] row_mask:0xf bank_mask:0xf
v_add_f32_dpp v58, v58, v58 quad_perm:[2,3,0,1] row_mask:0xf bank_mask:0xf
v_add_f32_dpp v59, v59, v59 quad_perm:[2,3,0,1] row_mask:0xf bank_mask:0xf
s_mov_b32 exec_lo, 0x330033
s_mov_b32 exec_hi, exec_lo
ds_write_b128 v24, v[56:59]
s_mov_b64 exec, -1
s_waitcnt lgkmcnt(0)
s_barrier
ds_read_b128 v[48:51], v25 offset:0
ds_read_b128 v[52:55], v25 offset:64
s_waitcnt lgkmcnt(0)
v_add_f32_dpp v48, v48, v48 quad_perm:[2,3,0,1] row_mask:0xf bank_mask:0xf
v_add_f32_dpp v49, v49, v49 quad_perm:[2,3,0,1] row_mask:0xf bank_mask:0xf
v_add_f32_dpp v50, v50, v50 quad_perm:[2,3,0,1] row_mask:0xf bank_mask:0xf
v_add_f32_dpp v51, v51, v51 quad_perm:[2,3,0,1] row_mask:0xf bank_mask:0xf
v_add_f32_dpp v52, v52, v52 quad_perm:[2,3,0,1] row_mask:0xf bank_mask:0xf
v_add_f32_dpp v53, v53, v53 quad_perm:[2,3,0,1] row_mask:0xf bank_mask:0xf
v_add_f32_dpp v54, v54, v54 quad_perm:[2,3,0,1] row_mask:0xf bank_mask:0xf
v_add_f32_dpp v55, v55, v55 quad_perm:[2,3,0,1] row_mask:0xf bank_mask:0xf
v_add_f32_dpp v48, v48, v48 row_ror:4 row_mask:0xf bank_mask:0xf
v_add_f32_dpp v49, v49, v49 row_ror:4 row_mask:0xf bank_mask:0xf
v_add_f32_dpp v50, v50, v50 row_ror:4 row_mask:0xf bank_mask:0xf
v_add_f32_dpp v51, v51, v51 row_ror:4 row_mask:0xf bank_mask:0xf
v_add_f32_dpp v52, v52, v52 row_ror:4 row_mask:0xf bank_mask:0xf
v_add_f32_dpp v53, v53, v53 row_ror:4 row_mask:0xf bank_mask:0xf
v_add_f32_dpp v54, v54, v54 row_ror:4 row_mask:0xf bank_mask:0xf
v_add_f32_dpp v55, v55, v55 row_ror:4 row_mask:0xf bank_mask:0xf
v_cvt_pk_bf16_f32 v56, v48, v49
v_cvt_pk_bf16_f32 v57, v50, v51
v_cvt_pk_bf16_f32 v58, v52, v53
v_cvt_pk_bf16_f32 v59, v54, v55
s_nop 1
v_mfma_f32_16x16x32_bf16 v[64:67], v[56:59], v[184:187], v[64:67]
s_nop 0
v_mfma_f32_16x16x32_bf16 v[68:71], v[56:59], v[188:191], v[68:71]
v_mfma_f32_16x16x32_bf16 v[72:75], v[56:59], v[192:195], v[72:75]
v_mfma_f32_16x16x32_bf16 v[76:79], v[56:59], v[196:199], v[76:79]
v_mfma_f32_16x16x32_bf16 v[80:83], v[56:59], v[200:203], v[80:83]
v_mfma_f32_16x16x32_bf16 v[84:87], v[56:59], v[204:207], v[84:87]
L_padh13:
s_cbranch_execz L_backh
v_mfma_f32_16x16x32_bf16 v[88:91], v[56:59], v[208:211], v[88:91]
v_mfma_f32_16x16x32_bf16 v[92:95], v[56:59], v[212:215], v[92:95]
v_mfma_f32_16x16x32_bf16 v[96:99], v[56:59], v[216:219], v[96:99]
v_mov_b32 v34, v4
v_mov_b32 v35, v4
v_mov_b32 v38, v4
v_mov_b32 v39, v4
s_mov_b64 exec, 0xffff
v_cvt_pk_bf16_f32 v32, v64, v65
v_cvt_pk_bf16_f32 v33, v68, v69
s_mov_b32 exec_lo, 0xffff0000
s_mov_b32 exec_hi, 0
v_cvt_pk_bf16_f32 v32, v72, v73
v_cvt_pk_bf16_f32 v33, v76, v77
s_mov_b32 exec_lo, 0x0
s_mov_b32 exec_hi, 0xffff
v_cvt_pk_bf16_f32 v32, v80, v81
v_cvt_pk_bf16_f32 v33, v84, v85
s_mov_b32 exec_lo, 0x0
s_mov_b32 exec_hi, 0xffff0000
v_cvt_pk_bf16_f32 v32, v88, v89
v_cvt_pk_bf16_f32 v33, v92, v93
s_mov_b64 exec, -1
buffer_store_dwordx4 v[32:35], v27, s[40:43], s60 offen sc1
v_cvt_pk_bf16_f32 v36, v96, v97
s_nop 1
v_mov_b32_dpp v37, v36 row_ror:8 row_mask:0xf bank_mask:0xf
s_mov_b64 exec, 0xff
buffer_store_dwordx4 v[36:39], v28, s[40:43], s60 offen sc1
s_mov_b64 exec, -1
s_branch L_done
L_gr_2:
s_sub_u32 s57, s57, 1
s_cbranch_scc1 L_end
s_add_u32 s22, s22, 1
s_cmp_gt_u32 s22, 12
s_cselect_b32 s101, 0x20000, 0
s_xor_b32 s63, s63, s101
s_cmp_lg_u32 s22, 10
s_cbranch_scc1 L_ga_3
s_mov_b32 exec_lo, 0xf000f
s_mov_b32 exec_hi, exec_lo
buffer_store_dwordx4 v[76:79], v64, s[40:43], s65 offen sc1
s_mov_b64 exec, -1
L_ga_3:
s_mov_b64 exec, s[4:5]
s_cbranch_execz L_gs_4
buffer_load_dwordx4 v[32:35], v65, s[40:43], s63 offen offset:0 sc1
L_gs_4:
s_mov_b64 exec, s[6:7]
s_cbranch_execz L_gs_5
buffer_load_dwordx4 v[36:39], v65, s[40:43], s63 offen offset:1024 sc1
L_gs_5:
s_mov_b64 exec, s[8:9]
s_cbranch_execz L_gs_6
buffer_load_dwordx4 v[40:43], v65, s[40:43], s63 offen offset:2048 sc1
L_gs_6:
s_mov_b64 exec, s[10:11]
s_cbranch_execz L_gs_7
buffer_load_dwordx4 v[44:47], v65, s[40:43], s63 offen offset:3072 sc1
L_gs_7:
s_mov_b64 exec, -1
s_waitcnt vmcnt(0)
s_branch L_gc_1
L_gr_9:
s_sub_u32 s22, s22, 1
s_cbranch_scc1 L_gb_10
s_mov_b64 exec, s[4:5]
buffer_load_dwordx4 v[32:35], v36, s[40:43], s58 offen sc1
s_mov_b64 exec, -1
s_waitcnt vmcnt(0)
s_branch L_gc_8
L_gr_13:
s_sub_u32 s57, s57, 1
s_cbranch_scc1 L_end
s_mov_b64 exec, s[4:5]
s_cbranch_execz L_gs_14
buffer_load_dwordx4 v[32:35], v26, s[40:43], s59 offen offset:0 sc1
L_gs_14:
s_mov_b64 exec, s[6:7]
s_cbranch_execz L_gs_15
buffer_load_dwordx4 v[36:39], v26, s[40:43], s59 offen offset:128 sc1
L_gs_15:
s_mov_b64 exec, s[8:9]
s_cbranch_execz L_gs_16
buffer_load_dwordx4 v[40:43], v26, s[40:43], s59 offen offset:256 sc1
L_gs_16:
s_mov_b64 exec, s[10:11]
s_cbranch_execz L_gs_17
buffer_load_dwordx4 v[44:47], v26, s[40:43], s59 offen offset:384 sc1
L_gs_17:
s_mov_b64 exec, -1
s_waitcnt vmcnt(0)
s_branch L_gc_12
L_attn:
s_lshr_b32 s55, s52, 2
s_lshl4_add_u32 s58, s52, s53
s_lshl_b32 s58, s58, 17
s_lshl_b32 s59, s3, 15
v_mov_b32 v8, v3
v_xor_b32 v9, 0x20, v3
v_xor_b32 v10, 0x40, v3
v_xor_b32 v11, 0x60, v3
v_xor_b32 v12, 0x90, v3
v_xor_b32 v13, 0xb0, v3
v_xor_b32 v14, 0xd0, v3
v_xor_b32 v15, 0xf0, v3
s_getreg_b32 s67, hwreg(HW_REG_XCC_ID, 0, 4)
s_waitcnt lgkmcnt(0)
s_load_dword s56, s[26:27], 0
s_add_u32 s28, s6, s58
s_addc_u32 s29, s7, 0
s_mov_b32 s30, 0x20000
s_mov_b32 s31, 0x20000
s_mov_b32 s40, s26
s_mov_b32 s41, s27
s_mov_b32 s42, 0xa00000
s_mov_b32 s43, 0x20000
s_mov_b32 s32, s4
s_mov_b32 s33, s5
s_mov_b32 s34, 0x900
s_mov_b32 s35, 0x20000
s_mov_b32 s44, s22
s_mov_b32 s45, s23
s_mov_b32 s46, 0x900
s_mov_b32 s47, 0x20000
s_lshl2_add_u32 s23, s53, s3
s_cmp_ge_u32 s23, 15
s_cbranch_scc1 L_backa
s_mov_b64 exec, 0
s_cmp_lt_u32 s23, 7
s_cbranch_scc0 L_wta7
s_cmp_lt_u32 s23, 3
s_cbranch_scc0 L_wta3
s_cmp_lt_u32 s23, 1
s_cbranch_scc0 L_wta1
s_branch L_pada0
L_wta1:
s_cmp_lt_u32 s23, 2
s_cbranch_scc0 L_wta2
s_branch L_pada1
L_wta2:
s_branch L_pada2
L_wta3:
s_cmp_lt_u32 s23, 5
s_cbranch_scc0 L_wta5
s_cmp_lt_u32 s23, 4
s_cbranch_scc0 L_wta4
s_branch L_pada3
L_wta4:
s_branch L_pada4
L_wta5:
s_cmp_lt_u32 s23, 6
s_cbranch_scc0 L_wta6
s_branch L_pada5
L_wta6:
s_branch L_pada6
L_wta7:
s_cmp_lt_u32 s23, 11
s_cbranch_scc0 L_wta11
s_cmp_lt_u32 s23, 9
s_cbranch_scc0 L_wta9
s_cmp_lt_u32 s23, 8
s_cbranch_scc0 L_wta8
s_branch L_pada7
L_wta8:
s_branch L_pada8
L_wta9:
s_cmp_lt_u32 s23, 10
s_cbranch_scc0 L_wta10
s_branch L_pada9
L_wta10:
s_branch L_pada10
L_wta11:
s_cmp_lt_u32 s23, 13
s_cbranch_scc0 L_wta13
s_cmp_lt_u32 s23, 12
s_cbranch_scc0 L_wta12
s_branch L_pada11
L_wta12:
s_branch L_pada12
L_wta13:
s_cmp_lt_u32 s23, 14
s_cbranch_scc0 L_wta14
s_branch L_pada13
L_wta14:
s_branch L_pada14
L_backa:
s_mov_b64 exec, -1
v_and_b32 v5, 7, v2
v_lshlrev_b32 v5, 1, v5
v_bfe_u32 v6, v2, 2, 1
v_or_b32 v5, v5, v6
v_xor_b32 v5, v5, v1
v_lshlrev_b32 v5, 4, v5
v_lshl_add_u32 v5, v2, 10, v5
v_add_u32 v16, s59, v5
v_xor_b32 v17, 64, v16
v_xor_b32 v18, 0x80, v16
v_xor_b32 v19, 0xc0, v16
v_xor_b32 v5, v1, v2
v_lshlrev_b32 v5, 4, v5
v_lshl_add_u32 v5, v2, 10, v5
v_add_u32 v20, 131072, v5
v_xor_b32 v21, 64, v20
v_xor_b32 v22, 0x80, v20
v_xor_b32 v23, 0xc0, v20
s_lshl_b32 s60, s3, 2
v_lshrrev_b32 v5, 1, v0
v_xor_b32 v5, s60, v5
v_lshlrev_b32 v5, 4, v5
v_and_b32 v6, 1, v0
v_lshl_add_u32 v5, v6, 3, v5
s_lshl_b32 s60, s3, 12
s_add_u32 s60, s60, 131072
v_add_u32 v24, s60, v5
v_xor_b32 v25, 16, v24
v_add_u32 v25, 0x400, v25
v_xor_b32 v26, 32, v24
v_add_u32 v26, 0x800, v26
v_xor_b32 v27, 48, v24
v_add_u32 v27, 0xc00, v27
v_bfe_u32 v5, v0, 2, 2
L_pada0:
s_cbranch_execz L_backa
v_and_b32 v6, 1, v1
v_lshl_add_u32 v6, v6, 2, v5
v_lshlrev_b32 v7, 1, v6
v_lshrrev_b32 v6, 2, v6
v_or_b32 v7, v7, v6
v_bfe_u32 v6, v0, 1, 1
v_xor_b32 v7, v7, v6
v_lshlrev_b32 v7, 4, v7
v_and_b32 v6, 1, v0
v_lshl_add_u32 v7, v6, 3, v7
v_lshl_add_u32 v5, v1, 2, v5
v_lshl_add_u32 v7, v5, 10, v7
s_lshl_b32 s60, s3, 8
v_add_u32 v96, s60, v7
v_xor_b32 v97, 0x20, v96
v_xor_b32 v98, 0x40, v96
v_xor_b32 v99, 0x60, v96
v_xor_b32 v100, 0x80, v96
v_xor_b32 v101, 0xa0, v96
v_xor_b32 v102, 0xc0, v96
v_xor_b32 v103, 0xe0, v96
v_add_u32 v104, 0x10000, v96
v_add_u32 v105, 0x10000, v97
v_add_u32 v106, 0x10000, v98
v_add_u32 v107, 0x10000, v99
v_add_u32 v108, 0x10000, v100
v_add_u32 v109, 0x10000, v101
v_add_u32 v110, 0x10000, v102
v_add_u32 v111, 0x10000, v103
s_lshl_b32 s60, s55, 16
s_add_u32 s60, s60, 524288
s_lshl_b32 s61, s3, 13
s_add_u32 s60, s60, s61
s_add_u32 s61, s60, 0x1000
s_add_u32 s62, s60, 0x8000
s_add_u32 s63, s60, 0x9000
v_lshlrev_b32 v5, 7, v2
s_lshl_b32 s64, s52, 11
s_add_u32 s64, s64, 4096
s_add_u32 m0, s59, 0
s_nop 0
buffer_load_dwordx4 v8, s[28:31], m0 offen offset:0 nt lds
buffer_load_dwordx4 v9, s[28:31], m0 offen offset:1024 nt lds
buffer_load_dwordx4 v10, s[28:31], m0 offen offset:2048 nt lds
v_lshrrev_b32 v30, 1, v2
v_mul_u32_u24 v30, 0x8200, v30
v_and_b32 v31, 1, v2
v_lshl_add_u32 v30, v31, 6, v30
v_lshl_add_u32 v30, v1, 4, v30
s_mul_i32 s65, s52, 532480
s_lshl_b32 s66, s3, 13
s_add_u32 s65, s65, s66
s_add_u32 s65, s65, 4194304
s_lshl_b32 s66, s53, 9
s_add_u32 s65, s65, s66
s_add_u32 s66, s65, 266240
v_mov_b32 v52, -1
v_mov_b32 v53, -1
v_mov_b32 v54, -1
v_mov_b32 v55, -1
buffer_store_dwordx4 v[52:55], v30, s[40:43], s65 offen offset:0
buffer_store_dwordx4 v[52:55], v30, s[40:43], s65 offen offset:128
buffer_store_dwordx4 v[52:55], v30, s[40:43], s65 offen offset:256
buffer_store_dwordx4 v[52:55], v30, s[40:43], s65 offen offset:384
buffer_store_dwordx4 v[52:55], v30, s[40:43], s66 offen offset:0
buffer_store_dwordx4 v[52:55], v30, s[40:43], s66 offen offset:128
buffer_store_dwordx4 v[52:55], v30, s[40:43], s66 offen offset:256
buffer_store_dwordx4 v[52:55], v30, s[40:43], s66 offen offset:384
s_waitcnt lgkmcnt(0)
s_mul_i32 s56, s56, 1664525
s_add_u32 s56, s56, 0x3c6ef35f
v_mov_b32 v4, s56
v_mov_b32 v120, s67
v_mov_b32 v121, s67
v_mov_b32 v122, v4
v_mov_b32 v123, v4
s_waitcnt vmcnt(2)
buffer_load_dwordx4 v11, s[28:31], m0 offen offset:3072 nt lds
s_waitcnt vmcnt(2)
s_add_u32 m0, s59, 4096
s_nop 0
buffer_load_dwordx4 v12, s[28:31], m0 offen offset:0 nt lds
L_pada1:
s_cbranch_execz L_backa
s_waitcnt vmcnt(2)
buffer_load_dwordx4 v13, s[28:31], m0 offen offset:1024 nt lds
buffer_load_dwordx4 v14, s[28:31], m0 offen offset:2048 nt lds
buffer_load_dwordx4 v15, s[28:31], m0 offen offset:3072 nt lds
s_add_u32 m0, s59, 8192
s_nop 0
buffer_load_dwordx4 v8, s[28:31], m0 offen offset:0 nt lds
buffer_load_dwordx4 v9, s[28:31], m0 offen offset:1024 nt lds
buffer_load_dwordx4 v10, s[28:31], m0 offen offset:2048 nt lds
buffer_load_dwordx4 v11, s[28:31], m0 offen offset:3072 nt lds
s_add_u32 m0, s59, 12288
s_nop 0
buffer_load_dwordx4 v12, s[28:31], m0 offen offset:0 nt lds
buffer_load_dwordx4 v13, s[28:31], m0 offen offset:1024 nt lds
buffer_load_dwordx4 v14, s[28:31], m0 offen offset:2048 nt lds
buffer_load_dwordx4 v15, s[28:31], m0 offen offset:3072 nt lds
s_add_u32 m0, s59, 16384
s_nop 0
buffer_load_dwordx4 v8, s[28:31], m0 offen offset:0 nt lds
buffer_load_dwordx4 v9, s[28:31], m0 offen offset:1024 nt lds
buffer_load_dwordx4 v10, s[28:31], m0 offen offset:2048 nt lds
buffer_load_dwordx4 v11, s[28:31], m0 offen offset:3072 nt lds
s_add_u32 m0, s59, 20480
s_nop 0
buffer_load_dwordx4 v12, s[28:31], m0 offen offset:0 nt lds
buffer_load_dwordx4 v13, s[28:31], m0 offen offset:1024 nt lds
buffer_load_dwordx4 v14, s[28:31], m0 offen offset:2048 nt lds
buffer_load_dwordx4 v15, s[28:31], m0 offen offset:3072 nt lds
s_add_u32 m0, s59, 24576
s_nop 0
buffer_load_dwordx4 v8, s[28:31], m0 offen offset:0 nt lds
buffer_load_dwordx4 v9, s[28:31], m0 offen offset:1024 nt lds
buffer_load_dwordx4 v10, s[28:31], m0 offen offset:2048 nt lds
buffer_load_dwordx4 v11, s[28:31], m0 offen offset:3072 nt lds
s_add_u32 m0, s59, 28672
s_nop 0
buffer_load_dwordx4 v12, s[28:31], m0 offen offset:0 nt lds
buffer_load_dwordx4 v13, s[28:31], m0 offen offset:1024 nt lds
buffer_load_dwordx4 v14, s[28:31], m0 offen offset:2048 nt lds
buffer_load_dwordx4 v15, s[28:31], m0 offen offset:3072 nt lds
s_barrier
s_cmp_lg_u32 s3, 0
s_cbranch_scc1 L_noid_18
s_lshl_b32 s65, s53, 7
s_add_u32 s65, s65, s64
s_mov_b64 exec, 0xff
buffer_store_dwordx4 v[120:123], v3, s[40:43], s65 offen sc1
s_mov_b64 exec, -1
L_noid_18:
v_not_b32 v50, v4
s_cmp_lg_u32 s3, 0
s_cbranch_scc1 L_nogo_19
s_lshl4_add_u32 s65, s52, s53
s_lshl_b32 s65, s65, 7
s_add_u32 s65, s65, 32768
s_mov_b64 exec, 0xff
buffer_store_dwordx4 v[48:51], v3, s[40:43], s65 offen
s_mov_b64 exec, -1
L_nogo_19:
s_lshl2_add_u32 s65, s52, s3
s_lshl4_add_u32 s65, s65, s53
s_lshl_b32 s65, s65, 9
s_add_u32 s65, s65, 786432
s_mov_b32 exec_lo, 0xffffffff
s_mov_b32 exec_hi, 0
buffer_store_dwordx4 v[48:51], v3, s[40:43], s65 offen
s_mov_b64 exec, -1
s_lshl_b32 s65, s3, 11
v_add_u32 v8, s65, v3
v_lshlrev_b32 v9, 5, v2
v_add_u32 v9, 8192, v9
s_lshl_b32 s65, s3, 2
v_add_u32 v10, s65, v9
s_waitcnt vmcnt(16)
ds_read_b128 a[128:131], v16 offset:0
ds_read_b128 a[132:135], v17 offset:0
ds_read_b128 a[136:139], v18 offset:0
ds_read_b128 a[140:143], v19 offset:0
ds_read_b128 a[144:147], v16 offset:256
ds_read_b128 a[148:151], v17 offset:256
ds_read_b128 a[152:155], v18 offset:256
L_pada2:
s_cbranch_execz L_backa
ds_read_b128 a[156:159], v19 offset:256
ds_read_b128 a[160:163], v16 offset:512
ds_read_b128 a[164:167], v17 offset:512
ds_read_b128 a[168:171], v18 offset:512
ds_read_b128 a[172:175], v19 offset:512
ds_read_b128 a[176:179], v16 offset:768
ds_read_b128 a[180:183], v17 offset:768
ds_read_b128 a[184:187], v18 offset:768
ds_read_b128 a[188:191], v19 offset:768
s_barrier
ds_read_b64_tr_b16 v[128:129], v96 offset:0
ds_read_b64_tr_b16 v[144:145], v97 offset:0
ds_read_b64_tr_b16 v[160:161], v98 offset:0
ds_read_b64_tr_b16 v[176:177], v99 offset:0
ds_read_b64_tr_b16 v[192:193], v100 offset:0
ds_read_b64_tr_b16 v[208:209], v101 offset:0
ds_read_b64_tr_b16 v[224:225], v102 offset:0
ds_read_b64_tr_b16 v[240:241], v103 offset:0
ds_read_b64_tr_b16 v[132:133], v96 offset:32768
ds_read_b64_tr_b16 v[148:149], v97 offset:32768
ds_read_b64_tr_b16 v[164:165], v98 offset:32768
ds_read_b64_tr_b16 v[180:181], v99 offset:32768
ds_read_b64_tr_b16 v[196:197], v100 offset:32768
ds_read_b64_tr_b16 v[212:213], v101 offset:32768
ds_read_b64_tr_b16 v[228:229], v102 offset:32768
ds_read_b64_tr_b16 v[244:245], v103 offset:32768
ds_read_b64_tr_b16 v[136:137], v104 offset:0
ds_read_b64_tr_b16 v[152:153], v105 offset:0
ds_read_b64_tr_b16 v[168:169], v106 offset:0
ds_read_b64_tr_b16 v[184:185], v107 offset:0
ds_read_b64_tr_b16 v[200:201], v108 offset:0
ds_read_b64_tr_b16 v[216:217], v109 offset:0
ds_read_b64_tr_b16 v[232:233], v110 offset:0
ds_read_b64_tr_b16 v[248:249], v111 offset:0
ds_read_b64_tr_b16 v[140:141], v104 offset:32768
ds_read_b64_tr_b16 v[156:157], v105 offset:32768
ds_read_b64_tr_b16 v[172:173], v106 offset:32768
ds_read_b64_tr_b16 v[188:189], v107 offset:32768
ds_read_b64_tr_b16 v[204:205], v108 offset:32768
ds_read_b64_tr_b16 v[220:221], v109 offset:32768
ds_read_b64_tr_b16 v[236:237], v110 offset:32768
ds_read_b64_tr_b16 v[252:253], v111 offset:32768
s_waitcnt vmcnt(8)
s_cmp_lg_u32 s3, 0
s_cbranch_scc1 L_nogo_20
s_lshl4_add_u32 s65, s52, s53
s_lshl_b32 s65, s65, 7
s_add_u32 s65, s65, 32768
s_mov_b64 exec, 0xff
buffer_store_dwordx4 v[120:123], v3, s[40:43], s65 offen
s_mov_b64 exec, -1
L_nogo_20:
s_waitcnt vmcnt(1)
s_cmp_eq_u32 s3, 0
s_cbranch_scc1 L_wl_21
s_waitcnt vmcnt(0)
L_wl_21:
buffer_load_dwordx4 v[32:35], v3, s[40:43], s60 offen offset:0
buffer_load_dwordx4 v[36:39], v3, s[40:43], s60 offen offset:1024
buffer_load_dwordx4 v[40:43], v3, s[40:43], s60 offen offset:2048
buffer_load_dwordx4 v[44:47], v3, s[40:43], s60 offen offset:3072
buffer_load_dwordx4 v[48:51], v3, s[40:43], s61 offen offset:0
buffer_load_dwordx4 v[52:55], v3, s[40:43], s61 offen offset:1024
buffer_load_dwordx4 v[56:59], v3, s[40:43], s61 offen offset:2048
buffer_load_dwordx4 v[60:63], v3, s[40:43], s61 offen offset:3072
ds_read_b128 a[192:195], v16 offset:16384
ds_read_b128 a[196:199], v17 offset:16384
ds_read_b128 a[200:203], v18 offset:16384
ds_read_b128 a[204:207], v19 offset:16384
ds_read_b128 a[208:211], v16 offset:16640
ds_read_b128 a[212:215], v17 offset:16640
L_pada3:
s_cbranch_execz L_backa
ds_read_b128 a[216:219], v18 offset:16640
ds_read_b128 a[220:223], v19 offset:16640
ds_read_b128 a[224:227], v16 offset:16896
ds_read_b128 a[228:231], v17 offset:16896
ds_read_b128 a[232:235], v18 offset:16896
ds_read_b128 a[236:239], v19 offset:16896
ds_read_b128 a[240:243], v16 offset:17152
ds_read_b128 a[244:247], v17 offset:17152
ds_read_b128 a[248:251], v18 offset:17152
ds_read_b128 a[252:255], v19 offset:17152
s_barrier
buffer_load_dwordx4 v[64:67], v3, s[40:43], s62 offen offset:0
buffer_load_dwordx4 v[68:71], v3, s[40:43], s62 offen offset:1024
buffer_load_dwordx4 v[72:75], v3, s[40:43], s62 offen offset:2048
buffer_load_dwordx4 v[76:79], v3, s[40:43], s62 offen offset:3072
buffer_load_dwordx4 v[80:83], v3, s[40:43], s63 offen offset:0
buffer_load_dwordx4 v[84:87], v3, s[40:43], s63 offen offset:1024
buffer_load_dwordx4 v[88:91], v3, s[40:43], s63 offen offset:2048
buffer_load_dwordx4 v[92:95], v3, s[40:43], s63 offen offset:3072
buffer_load_dwordx4 v[112:115], v5, s[40:43], s64 offen
ds_read_b64_tr_b16 v[130:131], v96 offset:16384
ds_read_b64_tr_b16 v[146:147], v97 offset:16384
ds_read_b64_tr_b16 v[162:163], v98 offset:16384
ds_read_b64_tr_b16 v[178:179], v99 offset:16384
ds_read_b64_tr_b16 v[194:195], v100 offset:16384
ds_read_b64_tr_b16 v[210:211], v101 offset:16384
ds_read_b64_tr_b16 v[226:227], v102 offset:16384
ds_read_b64_tr_b16 v[242:243], v103 offset:16384
ds_read_b64_tr_b16 v[134:135], v96 offset:49152
ds_read_b64_tr_b16 v[150:151], v97 offset:49152
ds_read_b64_tr_b16 v[166:167], v98 offset:49152
ds_read_b64_tr_b16 v[182:183], v99 offset:49152
ds_read_b64_tr_b16 v[198:199], v100 offset:49152
ds_read_b64_tr_b16 v[214:215], v101 offset:49152
ds_read_b64_tr_b16 v[230:231], v102 offset:49152
ds_read_b64_tr_b16 v[246:247], v103 offset:49152
ds_read_b64_tr_b16 v[138:139], v104 offset:16384
ds_read_b64_tr_b16 v[154:155], v105 offset:16384
ds_read_b64_tr_b16 v[170:171], v106 offset:16384
ds_read_b64_tr_b16 v[186:187], v107 offset:16384
ds_read_b64_tr_b16 v[202:203], v108 offset:16384
ds_read_b64_tr_b16 v[218:219], v109 offset:16384
ds_read_b64_tr_b16 v[234:235], v110 offset:16384
ds_read_b64_tr_b16 v[250:251], v111 offset:16384
ds_read_b64_tr_b16 v[142:143], v104 offset:49152
ds_read_b64_tr_b16 v[158:159], v105 offset:49152
ds_read_b64_tr_b16 v[174:175], v106 offset:49152
ds_read_b64_tr_b16 v[190:191], v107 offset:49152
ds_read_b64_tr_b16 v[206:207], v108 offset:49152
ds_read_b64_tr_b16 v[222:223], v109 offset:49152
ds_read_b64_tr_b16 v[238:239], v110 offset:49152
ds_read_b64_tr_b16 v[254:255], v111 offset:49152
s_mov_b32 s22, 0
L_gc_22:
s_waitcnt vmcnt(16)
v_cmp_ne_u32 s[4:5], s56, v34
ds_write_b64 v24, v[32:33] offset:0
s_waitcnt vmcnt(15)
v_cmp_ne_u32 s[6:7], s56, v38
ds_write_b64 v24, v[36:37] offset:512
s_or_b64 s[50:51], s[4:5], s[6:7]
s_waitcnt vmcnt(14)
v_cmp_ne_u32 s[8:9], s56, v42
ds_write_b64 v25, v[40:41] offset:0
s_or_b64 s[50:51], s[50:51], s[8:9]
s_waitcnt vmcnt(13)
v_cmp_ne_u32 s[10:11], s56, v46
ds_write_b64 v25, v[44:45] offset:512
s_or_b64 s[50:51], s[50:51], s[10:11]
L_pada4:
s_cbranch_execz L_backa
s_waitcnt vmcnt(12)
v_cmp_ne_u32 s[12:13], s56, v50
ds_write_b64 v26, v[48:49] offset:0
s_or_b64 s[50:51], s[50:51], s[12:13]
s_waitcnt vmcnt(11)
v_cmp_ne_u32 s[14:15], s56, v54
ds_write_b64 v26, v[52:53] offset:512
s_or_b64 s[50:51], s[50:51], s[14:15]
s_waitcnt vmcnt(10)
v_cmp_ne_u32 s[16:17], s56, v58
ds_write_b64 v27, v[56:57] offset:0
s_or_b64 s[50:51], s[50:51], s[16:17]
s_waitcnt vmcnt(9)
v_cmp_ne_u32 s[18:19], s56, v62
ds_write_b64 v27, v[60:61] offset:512
s_or_b64 s[50:51], s[50:51], s[18:19]
s_cmp_lg_u64 s[50:51], 0
s_cbranch_scc1 L_gr_23
s_waitcnt lgkmcnt(0)
s_barrier
ds_read_b128 a[0:3], v20 offset:0
ds_read_b128 a[4:7], v21 offset:0
ds_read_b128 a[8:11], v22 offset:0
ds_read_b128 a[12:15], v23 offset:0
ds_read_b128 a[16:19], v20 offset:256
ds_read_b128 a[20:23], v21 offset:256
ds_read_b128 a[24:27], v22 offset:256
ds_read_b128 a[28:31], v23 offset:256
ds_read_b128 a[32:35], v20 offset:512
ds_read_b128 a[36:39], v21 offset:512
ds_read_b128 a[40:43], v22 offset:512
ds_read_b128 a[44:47], v23 offset:512
ds_read_b128 a[48:51], v20 offset:768
ds_read_b128 a[52:55], v21 offset:768
ds_read_b128 a[56:59], v22 offset:768
ds_read_b128 a[60:63], v23 offset:768
s_mov_b32 s22, 0
s_waitcnt lgkmcnt(15)
v_mfma_f32_16x16x32_bf16 v[32:35], a[128:131], a[0:3], 0
v_mfma_f32_16x16x32_bf16 v[36:39], a[192:195], a[0:3], 0
s_waitcnt lgkmcnt(14)
v_mfma_f32_16x16x32_bf16 v[32:35], a[132:135], a[4:7], v[32:35]
v_mfma_f32_16x16x32_bf16 v[36:39], a[196:199], a[4:7], v[36:39]
s_waitcnt lgkmcnt(13)
v_mfma_f32_16x16x32_bf16 v[32:35], a[136:139], a[8:11], v[32:35]
v_mfma_f32_16x16x32_bf16 v[36:39], a[200:203], a[8:11], v[36:39]
s_waitcnt lgkmcnt(12)
v_mfma_f32_16x16x32_bf16 v[32:35], a[140:143], a[12:15], v[32:35]
v_mfma_f32_16x16x32_bf16 v[36:39], a[204:207], a[12:15], v[36:39]
s_waitcnt lgkmcnt(11)
v_mfma_f32_16x16x32_bf16 v[32:35], a[144:147], a[16:19], v[32:35]
v_mfma_f32_16x16x32_bf16 v[36:39], a[208:211], a[16:19], v[36:39]
s_waitcnt lgkmcnt(10)
v_mfma_f32_16x16x32_bf16 v[32:35], a[148:151], a[20:23], v[32:35]
v_mfma_f32_16x16x32_bf16 v[36:39], a[212:215], a[20:23], v[36:39]
s_waitcnt vmcnt(8)
v_cmp_ne_u32 s[4:5], s56, v66
ds_write_b64 v24, v[64:65] offset:16384
s_waitcnt lgkmcnt(10)
v_mfma_f32_16x16x32_bf16 v[32:35], a[152:155], a[24:27], v[32:35]
v_mfma_f32_16x16x32_bf16 v[36:39], a[216:219], a[24:27], v[36:39]
s_waitcnt vmcnt(7)
v_cmp_ne_u32 s[6:7], s56, v70
ds_write_b64 v24, v[68:69] offset:16896
s_or_b64 s[50:51], s[4:5], s[6:7]
s_waitcnt lgkmcnt(10)
v_mfma_f32_16x16x32_bf16 v[32:35], a[156:159], a[28:31], v[32:35]
v_mfma_f32_16x16x32_bf16 v[36:39], a[220:223], a[28:31], v[36:39]
s_waitcnt vmcnt(6)
v_cmp_ne_u32 s[8:9], s56, v74
ds_write_b64 v25, v[72:73] offset:16384
s_or_b64 s[50:51], s[50:51], s[8:9]
s_waitcnt lgkmcnt(10)
v_mfma_f32_16x16x32_bf16 v[32:35], a[160:163], a[32:35], v[32:35]
v_mfma_f32_16x16x32_bf16 v[36:39], a[224:227], a[32:35], v[36:39]
s_waitcnt vmcnt(5)
v_cmp_ne_u32 s[10:11], s56, v78
ds_write_b64 v25, v[76:77] offset:16896
L_pada5:
s_cbranch_execz L_backa
s_or_b64 s[50:51], s[50:51], s[10:11]
s_waitcnt lgkmcnt(10)
v_mfma_f32_16x16x32_bf16 v[32:35], a[164:167], a[36:39], v[32:35]
v_mfma_f32_16x16x32_bf16 v[36:39], a[228:231], a[36:39], v[36:39]
s_waitcnt vmcnt(4)
v_cmp_ne_u32 s[12:13], s56, v82
ds_write_b64 v26, v[80:81] offset:16384
s_or_b64 s[50:51], s[50:51], s[12:13]
s_waitcnt lgkmcnt(10)
v_mfma_f32_16x16x32_bf16 v[32:35], a[168:171], a[40:43], v[32:35]
v_mfma_f32_16x16x32_bf16 v[36:39], a[232:235], a[40:43], v[36:39]
s_waitcnt vmcnt(3)
v_cmp_ne_u32 s[14:15], s56, v86
ds_write_b64 v26, v[84:85] offset:16896
s_or_b64 s[50:51], s[50:51], s[14:15]
s_waitcnt lgkmcnt(10)
v_mfma_f32_16x16x32_bf16 v[32:35], a[172:175], a[44:47], v[32:35]
v_mfma_f32_16x16x32_bf16 v[36:39], a[236:239], a[44:47], v[36:39]
s_waitcnt vmcnt(2)
v_cmp_ne_u32 s[16:17], s56, v90
ds_write_b64 v27, v[88:89] offset:16384
s_or_b64 s[50:51], s[50:51], s[16:17]
s_waitcnt lgkmcnt(10)
v_mfma_f32_16x16x32_bf16 v[32:35], a[176:179], a[48:51], v[32:35]
v_mfma_f32_16x16x32_bf16 v[36:39], a[240:243], a[48:51], v[36:39]
s_waitcnt vmcnt(1)
v_cmp_ne_u32 s[18:19], s56, v94
ds_write_b64 v27, v[92:93] offset:16896
s_or_b64 s[50:51], s[50:51], s[18:19]
s_waitcnt lgkmcnt(10)
v_mfma_f32_16x16x32_bf16 v[32:35], a[180:183], a[52:55], v[32:35]
v_mfma_f32_16x16x32_bf16 v[36:39], a[244:247], a[52:55], v[36:39]
s_waitcnt vmcnt(0)
v_cmp_ne_u32 s[20:21], s56, v114
s_or_b64 s[50:51], s[50:51], s[20:21]
s_waitcnt lgkmcnt(9)
v_mfma_f32_16x16x32_bf16 v[32:35], a[184:187], a[56:59], v[32:35]
v_mfma_f32_16x16x32_bf16 v[36:39], a[248:251], a[56:59], v[36:39]
s_waitcnt lgkmcnt(8)
v_mfma_f32_16x16x32_bf16 v[32:35], a[188:191], a[60:63], v[32:35]
v_mfma_f32_16x16x32_bf16 v[36:39], a[252:255], a[60:63], v[36:39]
s_cmp_lg_u64 s[50:51], 0
s_cbranch_scc1 L_gr_33
L_gc_32:
v_cmp_ne_u32 vcc, s67, v112
s_mov_b64 s[48:49], vcc
s_nop 2
v_max3_f32 v56, v32, v33, v34
s_nop 2
v_max3_f32 v58, v35, v36, v37
s_nop 1
v_max3_f32 v56, v56, v38, v39
v_max_f32 v56, v56, v58
v_mov_b32 v58, v56
s_nop 1
v_permlane16_swap_b32 v58, v56
v_max_f32 v56, v56, v58
v_mov_b32 v58, v56
s_nop 1
v_permlane32_swap_b32 v58, v56
v_max_f32 v56, v56, v58
v_ceil_f32 v56, v56
ds_write_b32 v10, v56 offset:0
s_cmp_eq_u64 s[48:49], 0
s_cselect_b32 s67, 1, 0
s_waitcnt lgkmcnt(0)
s_barrier
ds_read_b128 v[60:63], v9
ds_read_b128 a[64:67], v20 offset:16384
ds_read_b128 a[68:71], v21 offset:16384
ds_read_b128 a[72:75], v22 offset:16384
ds_read_b128 a[76:79], v23 offset:16384
ds_read_b128 a[80:83], v20 offset:16640
ds_read_b128 a[84:87], v21 offset:16640
ds_read_b128 a[88:91], v22 offset:16640
ds_read_b128 a[92:95], v23 offset:16640
ds_read_b128 a[96:99], v20 offset:16896
ds_read_b128 a[100:103], v21 offset:16896
ds_read_b128 a[104:107], v22 offset:16896
ds_read_b128 a[108:111], v23 offset:16896
ds_read_b128 a[112:115], v20 offset:17152
ds_read_b128 a[116:119], v21 offset:17152
ds_read_b128 a[120:123], v22 offset:17152
ds_read_b128 a[124:127], v23 offset:17152
L_pada6:
s_cbranch_execz L_backa
s_waitcnt lgkmcnt(15)
v_mfma_f32_16x16x32_bf16 v[40:43], a[128:131], a[64:67], 0
v_mfma_f32_16x16x32_bf16 v[44:47], a[192:195], a[64:67], 0
s_waitcnt lgkmcnt(14)
v_mfma_f32_16x16x32_bf16 v[40:43], a[132:135], a[68:71], v[40:43]
v_max3_f32 v28, v60, v61, v62
v_mfma_f32_16x16x32_bf16 v[44:47], a[196:199], a[68:71], v[44:47]
v_max_f32 v28, v28, v63
s_waitcnt lgkmcnt(13)
v_mfma_f32_16x16x32_bf16 v[40:43], a[136:139], a[72:75], v[40:43]
v_sub_f32 v32, v32, v28
v_mfma_f32_16x16x32_bf16 v[44:47], a[200:203], a[72:75], v[44:47]
v_sub_f32 v33, v33, v28
s_waitcnt lgkmcnt(12)
v_mfma_f32_16x16x32_bf16 v[40:43], a[140:143], a[76:79], v[40:43]
v_sub_f32 v34, v34, v28
v_mfma_f32_16x16x32_bf16 v[44:47], a[204:207], a[76:79], v[44:47]
v_sub_f32 v35, v35, v28
s_waitcnt lgkmcnt(11)
v_mfma_f32_16x16x32_bf16 v[40:43], a[144:147], a[80:83], v[40:43]
v_sub_f32 v36, v36, v28
v_mfma_f32_16x16x32_bf16 v[44:47], a[208:211], a[80:83], v[44:47]
v_sub_f32 v37, v37, v28
s_waitcnt lgkmcnt(10)
v_mfma_f32_16x16x32_bf16 v[40:43], a[148:151], a[84:87], v[40:43]
v_sub_f32 v38, v38, v28
v_mfma_f32_16x16x32_bf16 v[44:47], a[212:215], a[84:87], v[44:47]
v_sub_f32 v39, v39, v28
s_waitcnt lgkmcnt(9)
v_mfma_f32_16x16x32_bf16 v[40:43], a[152:155], a[88:91], v[40:43]
v_exp_f32 v32, v32
v_mfma_f32_16x16x32_bf16 v[44:47], a[216:219], a[88:91], v[44:47]
v_exp_f32 v33, v33
s_waitcnt lgkmcnt(8)
v_mfma_f32_16x16x32_bf16 v[40:43], a[156:159], a[92:95], v[40:43]
v_exp_f32 v34, v34
v_mfma_f32_16x16x32_bf16 v[44:47], a[220:223], a[92:95], v[44:47]
v_exp_f32 v35, v35
s_waitcnt lgkmcnt(7)
v_mfma_f32_16x16x32_bf16 v[40:43], a[160:163], a[96:99], v[40:43]
v_exp_f32 v36, v36
v_mfma_f32_16x16x32_bf16 v[44:47], a[224:227], a[96:99], v[44:47]
v_exp_f32 v37, v37
s_waitcnt lgkmcnt(6)
v_mfma_f32_16x16x32_bf16 v[40:43], a[164:167], a[100:103], v[40:43]
v_exp_f32 v38, v38
v_mfma_f32_16x16x32_bf16 v[44:47], a[228:231], a[100:103], v[44:47]
v_exp_f32 v39, v39
s_waitcnt lgkmcnt(5)
v_mfma_f32_16x16x32_bf16 v[40:43], a[168:171], a[104:107], v[40:43]
v_cvt_pk_bf16_f32 v48, v32, v33
v_mfma_f32_16x16x32_bf16 v[44:47], a[232:235], a[104:107], v[44:47]
v_cvt_pk_bf16_f32 v49, v34, v35
s_waitcnt lgkmcnt(4)
v_mfma_f32_16x16x32_bf16 v[40:43], a[172:175], a[108:111], v[40:43]
v_cvt_pk_bf16_f32 v50, v36, v37
v_mfma_f32_16x16x32_bf16 v[44:47], a[236:239], a[108:111], v[44:47]
v_cvt_pk_bf16_f32 v51, v38, v39
s_waitcnt lgkmcnt(3)
v_mfma_f32_16x16x32_bf16 v[40:43], a[176:179], a[112:115], v[40:43]
ds_write_b128 v8, v[48:51] offset:0
v_mfma_f32_16x16x32_bf16 v[44:47], a[240:243], a[112:115], v[44:47]
s_waitcnt lgkmcnt(3)
v_mfma_f32_16x16x32_bf16 v[40:43], a[180:183], a[116:119], v[40:43]
v_mfma_f32_16x16x32_bf16 v[44:47], a[244:247], a[116:119], v[44:47]
s_waitcnt lgkmcnt(2)
v_mfma_f32_16x16x32_bf16 v[40:43], a[184:187], a[120:123], v[40:43]
v_mfma_f32_16x16x32_bf16 v[44:47], a[248:251], a[120:123], v[44:47]
s_waitcnt lgkmcnt(1)
v_mfma_f32_16x16x32_bf16 v[40:43], a[188:191], a[124:127], v[40:43]
v_mfma_f32_16x16x32_bf16 v[44:47], a[252:255], a[124:127], v[44:47]
s_mul_i32 s63, s52, 532480
s_lshl_b32 s61, s3, 13
s_add_u32 s63, s63, s61
s_add_u32 s63, s63, 4194304
s_lshl_b32 s61, s53, 9
s_add_u32 s60, s63, s61
s_add_u32 s61, s60, 266240
s_lshl_b32 s62, s53, 9
s_lshl2_add_u32 s64, s52, s3
s_lshl_b32 s64, s64, 13
s_add_u32 s64, s64, 786432
s_add_u32 s62, s62, s64
v_mov_b32 v24, 0x3f803f80
L_pada7:
s_cbranch_execz L_backa
v_mov_b32 v25, 0x3f803f80
v_mov_b32 v26, 0x3f803f80
v_mov_b32 v27, 0x3f803f80
v_add_u32 v11, 0, v3
v_and_b32 v5, 3, v2
v_lshlrev_b32 v7, 4, v5
v_lshl_add_u32 v5, v5, 2, v1
v_lshlrev_b32 v5, 9, v5
v_lshrrev_b32 v6, 3, v2
v_lshl_add_u32 v5, v6, 4, v5
v_lshl_add_u32 v7, v6, 6, v7
v_lshl_add_u32 v7, v1, 9, v7
v_bfe_u32 v31, v2, 2, 1
v_lshl_add_u32 v7, v31, 7, v7
v_max3_f32 v56, v40, v41, v42
v_max3_f32 v58, v43, v44, v45
v_max3_f32 v56, v56, v46, v47
v_max_f32 v56, v56, v58
v_mov_b32 v58, v56
s_nop 1
v_permlane16_swap_b32 v58, v56
v_max_f32 v56, v56, v58
v_mov_b32 v58, v56
s_nop 1
v_permlane32_swap_b32 v58, v56
v_max_f32 v56, v56, v58
v_ceil_f32 v56, v56
ds_write_b32 v10, v56 offset:16
s_cmp_eq_u32 s67, 0
s_waitcnt lgkmcnt(0)
s_barrier
s_cbranch_scc1 L_pv_far
ds_read_b128 v[96:99], v11 offset:0
ds_read_b128 v[100:103], v11 offset:2048
ds_read_b128 v[104:107], v11 offset:4096
ds_read_b128 v[108:111], v11 offset:6144
ds_read_b128 v[60:63], v9 offset:16
s_waitcnt lgkmcnt(4)
v_mfma_f32_16x16x32_bf16 v[64:67], v[128:131], v[96:99], 0
v_mfma_f32_16x16x32_bf16 v[68:71], v[144:147], v[96:99], 0
s_waitcnt lgkmcnt(0)
v_max3_f32 v29, v60, v61, v62
v_mfma_f32_16x16x32_bf16 v[72:75], v[160:163], v[96:99], 0
v_max_f32 v29, v29, v63
v_sub_f32 v40, v40, v29
v_mfma_f32_16x16x32_bf16 v[76:79], v[176:179], v[96:99], 0
v_sub_f32 v41, v41, v29
v_sub_f32 v42, v42, v29
s_waitcnt lgkmcnt(3)
v_mfma_f32_16x16x32_bf16 v[64:67], v[132:135], v[100:103], v[64:67]
v_sub_f32 v43, v43, v29
v_sub_f32 v44, v44, v29
v_mfma_f32_16x16x32_bf16 v[68:71], v[148:151], v[100:103], v[68:71]
v_sub_f32 v45, v45, v29
v_sub_f32 v46, v46, v29
v_mfma_f32_16x16x32_bf16 v[72:75], v[164:167], v[100:103], v[72:75]
v_sub_f32 v47, v47, v29
v_exp_f32 v40, v40
v_mfma_f32_16x16x32_bf16 v[76:79], v[180:183], v[100:103], v[76:79]
v_exp_f32 v41, v41
v_exp_f32 v42, v42
s_waitcnt lgkmcnt(2)
v_mfma_f32_16x16x32_bf16 v[64:67], v[136:139], v[104:107], v[64:67]
v_exp_f32 v43, v43
v_exp_f32 v44, v44
v_mfma_f32_16x16x32_bf16 v[68:71], v[152:155], v[104:107], v[68:71]
v_exp_f32 v45, v45
v_exp_f32 v46, v46
v_mfma_f32_16x16x32_bf16 v[72:75], v[168:171], v[104:107], v[72:75]
v_exp_f32 v47, v47
v_cvt_pk_bf16_f32 v48, v40, v41
v_mfma_f32_16x16x32_bf16 v[76:79], v[184:187], v[104:107], v[76:79]
v_cvt_pk_bf16_f32 v49, v42, v43
v_cvt_pk_bf16_f32 v50, v44, v45
s_waitcnt lgkmcnt(1)
v_mfma_f32_16x16x32_bf16 v[64:67], v[140:143], v[108:111], v[64:67]
v_cvt_pk_bf16_f32 v51, v46, v47
ds_write_b128 v8, v[48:51] offset:1024
v_mfma_f32_16x16x32_bf16 v[68:71], v[156:159], v[108:111], v[68:71]
v_mfma_f32_16x16x32_bf16 v[72:75], v[172:175], v[108:111], v[72:75]
v_mfma_f32_16x16x32_bf16 v[76:79], v[188:191], v[108:111], v[76:79]
v_mfma_f32_16x16x32_bf16 v[80:83], v[192:195], v[96:99], 0
v_mfma_f32_16x16x32_bf16 v[84:87], v[208:211], v[96:99], 0
v_mfma_f32_16x16x32_bf16 v[88:91], v[224:227], v[96:99], 0
L_pada8:
s_cbranch_execz L_backa
v_mfma_f32_16x16x32_bf16 v[92:95], v[240:243], v[96:99], 0
s_waitcnt lgkmcnt(0)
s_barrier
v_mfma_f32_16x16x32_bf16 v[80:83], v[196:199], v[100:103], v[80:83]
ds_read_b128 v[112:115], v11 offset:1024
ds_read_b128 v[116:119], v11 offset:3072
ds_read_b128 v[120:123], v11 offset:5120
ds_read_b128 v[124:127], v11 offset:7168
v_mfma_f32_16x16x32_bf16 v[84:87], v[212:215], v[100:103], v[84:87]
v_cvt_pk_bf16_f32 v64, v64, v65
v_mfma_f32_16x16x32_bf16 v[88:91], v[228:231], v[100:103], v[88:91]
v_cvt_pk_bf16_f32 v65, v66, v67
v_mfma_f32_16x16x32_bf16 v[92:95], v[244:247], v[100:103], v[92:95]
v_cvt_pk_bf16_f32 v66, v68, v69
v_mfma_f32_16x16x32_bf16 v[80:83], v[200:203], v[104:107], v[80:83]
v_cvt_pk_bf16_f32 v67, v70, v71
v_mfma_f32_16x16x32_bf16 v[84:87], v[216:219], v[104:107], v[84:87]
v_min_u32 v64, -2, v64
v_mfma_f32_16x16x32_bf16 v[88:91], v[232:235], v[104:107], v[88:91]
buffer_store_dwordx4 v[64:67], v30, s[40:43], s60 offen offset:0
v_mfma_f32_16x16x32_bf16 v[92:95], v[248:251], v[104:107], v[92:95]
v_cvt_pk_bf16_f32 v72, v72, v73
v_mfma_f32_16x16x32_bf16 v[80:83], v[204:207], v[108:111], v[80:83]
v_cvt_pk_bf16_f32 v73, v74, v75
v_mfma_f32_16x16x32_bf16 v[84:87], v[220:223], v[108:111], v[84:87]
v_cvt_pk_bf16_f32 v74, v76, v77
v_mfma_f32_16x16x32_bf16 v[88:91], v[236:239], v[108:111], v[88:91]
v_cvt_pk_bf16_f32 v75, v78, v79
v_mfma_f32_16x16x32_bf16 v[92:95], v[252:255], v[108:111], v[92:95]
v_min_u32 v72, -2, v72
s_waitcnt lgkmcnt(0)
v_mfma_f32_16x16x32_bf16 v[16:19], v[24:27], v[96:99], 0
buffer_store_dwordx4 v[72:75], v30, s[40:43], s60 offen offset:128
v_mfma_f32_16x16x32_bf16 v[20:23], v[24:27], v[112:115], 0
v_mfma_f32_16x16x32_bf16 v[16:19], v[24:27], v[100:103], v[16:19]
v_cvt_pk_bf16_f32 v80, v80, v81
v_cvt_pk_bf16_f32 v81, v82, v83
v_mfma_f32_16x16x32_bf16 v[20:23], v[24:27], v[116:119], v[20:23]
v_cvt_pk_bf16_f32 v82, v84, v85
v_cvt_pk_bf16_f32 v83, v86, v87
v_mfma_f32_16x16x32_bf16 v[16:19], v[24:27], v[104:107], v[16:19]
v_min_u32 v80, -2, v80
buffer_store_dwordx4 v[80:83], v30, s[40:43], s60 offen offset:256
v_mfma_f32_16x16x32_bf16 v[20:23], v[24:27], v[120:123], v[20:23]
v_cvt_pk_bf16_f32 v88, v88, v89
v_cvt_pk_bf16_f32 v89, v90, v91
v_mfma_f32_16x16x32_bf16 v[16:19], v[24:27], v[108:111], v[16:19]
v_cvt_pk_bf16_f32 v90, v92, v93
v_cvt_pk_bf16_f32 v91, v94, v95
v_mfma_f32_16x16x32_bf16 v[20:23], v[24:27], v[124:127], v[20:23]
v_min_u32 v88, -2, v88
buffer_store_dwordx4 v[88:91], v30, s[40:43], s60 offen offset:384
v_mfma_f32_16x16x32_bf16 v[32:35], v[128:131], v[112:115], 0
v_mfma_f32_16x16x32_bf16 v[36:39], v[144:147], v[112:115], 0
v_mfma_f32_16x16x32_bf16 v[40:43], v[160:163], v[112:115], 0
s_mov_b32 s48, 0xffff
s_mov_b32 s49, s48
v_mfma_f32_16x16x32_bf16 v[44:47], v[176:179], v[112:115], 0
v_cndmask_b32 v12, v29, v28, s[48:49]
v_cndmask_b32 v13, v20, v16, s[48:49]
v_mfma_f32_16x16x32_bf16 v[32:35], v[132:135], v[116:119], v[32:35]
v_mov_b32 v14, v4
v_mov_b32 v15, v4
v_mfma_f32_16x16x32_bf16 v[36:39], v[148:151], v[116:119], v[36:39]
v_mfma_f32_16x16x32_bf16 v[40:43], v[164:167], v[116:119], v[40:43]
s_mov_b32 exec_lo, 0xffffffff
s_mov_b32 exec_hi, 0
buffer_store_dwordx4 v[12:15], v3, s[40:43], s62 offen
s_mov_b64 exec, -1
v_mfma_f32_16x16x32_bf16 v[44:47], v[180:183], v[116:119], v[44:47]
L_pada9:
s_cbranch_execz L_backa
v_mfma_f32_16x16x32_bf16 v[32:35], v[136:139], v[120:123], v[32:35]
v_mfma_f32_16x16x32_bf16 v[36:39], v[152:155], v[120:123], v[36:39]
v_mfma_f32_16x16x32_bf16 v[40:43], v[168:171], v[120:123], v[40:43]
v_mfma_f32_16x16x32_bf16 v[44:47], v[184:187], v[120:123], v[44:47]
v_mfma_f32_16x16x32_bf16 v[32:35], v[140:143], v[124:127], v[32:35]
v_mfma_f32_16x16x32_bf16 v[36:39], v[156:159], v[124:127], v[36:39]
v_mfma_f32_16x16x32_bf16 v[40:43], v[172:175], v[124:127], v[40:43]
v_mfma_f32_16x16x32_bf16 v[44:47], v[188:191], v[124:127], v[44:47]
v_mfma_f32_16x16x32_bf16 v[48:51], v[192:195], v[112:115], 0
v_mfma_f32_16x16x32_bf16 v[52:55], v[208:211], v[112:115], 0
v_mfma_f32_16x16x32_bf16 v[56:59], v[224:227], v[112:115], 0
s_nop 1
v_cvt_pk_bf16_f32 v32, v32, v33
v_mfma_f32_16x16x32_bf16 v[60:63], v[240:243], v[112:115], 0
v_cvt_pk_bf16_f32 v33, v34, v35
v_mfma_f32_16x16x32_bf16 v[48:51], v[196:199], v[116:119], v[48:51]
v_cvt_pk_bf16_f32 v34, v36, v37
v_mfma_f32_16x16x32_bf16 v[52:55], v[212:215], v[116:119], v[52:55]
v_cvt_pk_bf16_f32 v35, v38, v39
v_mfma_f32_16x16x32_bf16 v[56:59], v[228:231], v[116:119], v[56:59]
v_min_u32 v32, -2, v32
v_mfma_f32_16x16x32_bf16 v[60:63], v[244:247], v[116:119], v[60:63]
buffer_store_dwordx4 v[32:35], v30, s[40:43], s61 offen offset:0
v_mfma_f32_16x16x32_bf16 v[48:51], v[200:203], v[120:123], v[48:51]
v_cvt_pk_bf16_f32 v40, v40, v41
v_mfma_f32_16x16x32_bf16 v[52:55], v[216:219], v[120:123], v[52:55]
v_cvt_pk_bf16_f32 v41, v42, v43
v_mfma_f32_16x16x32_bf16 v[56:59], v[232:235], v[120:123], v[56:59]
v_cvt_pk_bf16_f32 v42, v44, v45
v_mfma_f32_16x16x32_bf16 v[60:63], v[248:251], v[120:123], v[60:63]
v_cvt_pk_bf16_f32 v43, v46, v47
v_mfma_f32_16x16x32_bf16 v[48:51], v[204:207], v[124:127], v[48:51]
v_min_u32 v40, -2, v40
v_mfma_f32_16x16x32_bf16 v[52:55], v[220:223], v[124:127], v[52:55]
buffer_store_dwordx4 v[40:43], v30, s[40:43], s61 offen offset:128
v_mfma_f32_16x16x32_bf16 v[56:59], v[236:239], v[124:127], v[56:59]
v_mfma_f32_16x16x32_bf16 v[60:63], v[252:255], v[124:127], v[60:63]
s_nop 2
v_cvt_pk_bf16_f32 v48, v48, v49
s_nop 1
v_cvt_pk_bf16_f32 v49, v50, v51
s_nop 2
v_cvt_pk_bf16_f32 v50, v52, v53
s_nop 1
v_cvt_pk_bf16_f32 v51, v54, v55
v_min_u32 v48, -2, v48
buffer_store_dwordx4 v[48:51], v30, s[40:43], s61 offen offset:256
s_nop 0
v_cvt_pk_bf16_f32 v56, v56, v57
v_cvt_pk_bf16_f32 v57, v58, v59
v_cvt_pk_bf16_f32 v58, v60, v61
v_cvt_pk_bf16_f32 v59, v62, v63
v_min_u32 v56, -2, v56
buffer_store_dwordx4 v[56:59], v30, s[40:43], s61 offen offset:384
L_pv_done:
s_lshl_b32 s60, s53, 5
s_add_u32 s64, s64, s60
buffer_load_dwordx4 v[32:35], v5, s[40:43], s64 offen sc1
s_mul_i32 s60, s53, 33280
s_add_u32 s60, s60, s63
s_add_u32 s61, s60, 0x1000
buffer_load_dwordx4 v[64:67], v7, s[40:43], s60 offen offset:0 sc1
buffer_load_dwordx4 v[68:71], v7, s[40:43], s60 offen offset:256 sc1
buffer_load_dwordx4 v[72:75], v7, s[40:43], s60 offen offset:2048 sc1
buffer_load_dwordx4 v[76:79], v7, s[40:43], s60 offen offset:2304 sc1
buffer_load_dwordx4 v[80:83], v7, s[40:43], s61 offen offset:0 sc1
buffer_load_dwordx4 v[84:87], v7, s[40:43], s61 offen offset:256 sc1
buffer_load_dwordx4 v[88:91], v7, s[40:43], s61 offen offset:2048 sc1
buffer_load_dwordx4 v[92:95], v7, s[40:43], s61 offen offset:2304 sc1
v_and_b32 v8, 1, v2
v_lshlrev_b32 v8, 4, v8
v_mov_b32 v9, 0xffff
L_pada10:
s_cbranch_execz L_backa
v_lshlrev_b32 v8, v8, v9
v_bfe_u32 v9, v2, 1, 2
v_cmp_eq_u32 vcc, 0, v9
s_nop 1
v_cndmask_b32 v112, 0, v8, vcc
v_cmp_eq_u32 vcc, 1, v9
s_nop 1
v_cndmask_b32 v113, 0, v8, vcc
v_cmp_eq_u32 vcc, 2, v9
s_nop 1
v_cndmask_b32 v114, 0, v8, vcc
v_cmp_eq_u32 vcc, 3, v9
s_nop 1
v_cndmask_b32 v115, 0, v8, vcc
v_lshrrev_b32 v9, 1, v1
v_lshlrev_b32 v8, 4, v9
v_bfe_u32 v9, v2, 2, 1
v_lshl_add_u32 v8, v9, 3, v8
v_and_b32 v9, 1, v1
v_lshl_add_u32 v8, v9, 2, v8
v_and_b32 v9, 3, v2
v_add_u32 v8, v8, v9
v_lshlrev_b32 v8, 4, v8
v_lshl_add_u32 v8, v6, 14, v8
s_lshl_b32 s62, s53, 15
s_lshl_b32 s65, s3, 12
s_add_u32 s62, s62, s65
s_lshl_b32 s65, s52, 9
s_add_u32 s62, s62, s65
s_add_u32 s62, s62, 1048576
s_mov_b32 s48, 0xaaaaaaaa
s_mov_b32 s49, s48
s_mov_b32 s101, s67
L_gc_43:
s_waitcnt vmcnt(8)
v_cmp_ne_u32 s[4:5], s56, v34
s_cmp_lg_u64 s[4:5], 0
s_cbranch_scc1 L_gr_44
s_cmp_lg_u32 s101, 0
s_cbranch_scc1 L_noreload
s_waitcnt vmcnt(0)
buffer_load_dwordx4 v[64:67], v7, s[40:43], s60 offen offset:0 sc1
buffer_load_dwordx4 v[68:71], v7, s[40:43], s60 offen offset:256 sc1
buffer_load_dwordx4 v[72:75], v7, s[40:43], s60 offen offset:2048 sc1
buffer_load_dwordx4 v[76:79], v7, s[40:43], s60 offen offset:2304 sc1
buffer_load_dwordx4 v[80:83], v7, s[40:43], s61 offen offset:0 sc1
buffer_load_dwordx4 v[84:87], v7, s[40:43], s61 offen offset:256 sc1
buffer_load_dwordx4 v[88:91], v7, s[40:43], s61 offen offset:2048 sc1
buffer_load_dwordx4 v[92:95], v7, s[40:43], s61 offen offset:2304 sc1
L_noreload:
v_max_f32_dpp v36, v32, v32 quad_perm:[1,0,3,2] row_mask:0xf bank_mask:0xf
s_nop 1
v_max_f32_dpp v36, v36, v36 quad_perm:[2,3,0,1] row_mask:0xf bank_mask:0xf
v_mov_b32 v37, v36
s_nop 1
v_permlane16_swap_b32 v37, v36
v_max_f32 v36, v36, v37
v_mov_b32 v37, v36
s_nop 1
v_permlane32_swap_b32 v37, v36
v_max_f32 v36, v36, v37
v_sub_f32 v37, v32, v36
v_exp_f32 v37, v37
s_nop 0
v_mul_f32 v38, v37, v33
v_cvt_pk_bf16_f32 v37, v37, v37
s_nop 1
v_and_b32_dpp v96, v37, v112 quad_perm:[0,0,0,0] row_mask:0xf bank_mask:0xf
s_nop 0
v_and_b32_dpp v97, v37, v113 quad_perm:[0,0,0,0] row_mask:0xf bank_mask:0xf
v_and_b32_dpp v98, v37, v114 quad_perm:[0,0,0,0] row_mask:0xf bank_mask:0xf
v_and_b32_dpp v99, v37, v115 quad_perm:[0,0,0,0] row_mask:0xf bank_mask:0xf
v_and_b32_dpp v100, v37, v112 quad_perm:[1,1,1,1] row_mask:0xf bank_mask:0xf
v_and_b32_dpp v101, v37, v113 quad_perm:[1,1,1,1] row_mask:0xf bank_mask:0xf
v_and_b32_dpp v102, v37, v114 quad_perm:[1,1,1,1] row_mask:0xf bank_mask:0xf
v_and_b32_dpp v103, v37, v115 quad_perm:[1,1,1,1] row_mask:0xf bank_mask:0xf
v_and_b32_dpp v104, v37, v112 quad_perm:[2,2,2,2] row_mask:0xf bank_mask:0xf
v_and_b32_dpp v105, v37, v113 quad_perm:[2,2,2,2] row_mask:0xf bank_mask:0xf
v_and_b32_dpp v106, v37, v114 quad_perm:[2,2,2,2] row_mask:0xf bank_mask:0xf
v_and_b32_dpp v107, v37, v115 quad_perm:[2,2,2,2] row_mask:0xf bank_mask:0xf
v_and_b32_dpp v108, v37, v112 quad_perm:[3,3,3,3] row_mask:0xf bank_mask:0xf
v_and_b32_dpp v109, v37, v113 quad_perm:[3,3,3,3] row_mask:0xf bank_mask:0xf
v_and_b32_dpp v110, v37, v114 quad_perm:[3,3,3,3] row_mask:0xf bank_mask:0xf
v_and_b32_dpp v111, v37, v115 quad_perm:[3,3,3,3] row_mask:0xf bank_mask:0xf
v_add_f32_dpp v38, v38, v38 quad_perm:[1,0,3,2] row_mask:0xf bank_mask:0xf
s_nop 1
v_add_f32_dpp v38, v38, v38 quad_perm:[2,3,0,1] row_mask:0xf bank_mask:0xf
v_mov_b32 v39, v38
s_nop 1
v_permlane16_swap_b32 v39, v38
v_add_f32 v38, v38, v39
L_pada11:
s_cbranch_execz L_backa
v_mov_b32 v39, v38
s_nop 1
v_permlane32_swap_b32 v39, v38
v_add_f32 v38, v38, v39
v_cndmask_b32 v51, v36, v38, s[48:49]
v_mov_b32 v50, v4
L_gc_46:
s_waitcnt vmcnt(7)
v_cmp_eq_u32 s[4:5], -1, v64
v_mfma_f32_16x16x32_bf16 v[40:43], v[96:99], v[64:67], 0
s_waitcnt vmcnt(6)
v_cmp_eq_u32 s[6:7], -1, v68
v_mfma_f32_16x16x32_bf16 v[44:47], v[96:99], v[68:71], 0
s_or_b64 s[50:51], s[4:5], s[6:7]
s_waitcnt vmcnt(5)
v_cmp_eq_u32 s[8:9], -1, v72
v_mfma_f32_16x16x32_bf16 v[40:43], v[100:103], v[72:75], v[40:43]
s_or_b64 s[50:51], s[50:51], s[8:9]
s_waitcnt vmcnt(4)
v_cmp_eq_u32 s[10:11], -1, v76
v_mfma_f32_16x16x32_bf16 v[44:47], v[100:103], v[76:79], v[44:47]
s_or_b64 s[50:51], s[50:51], s[10:11]
s_waitcnt vmcnt(3)
v_cmp_eq_u32 s[12:13], -1, v80
v_mfma_f32_16x16x32_bf16 v[40:43], v[104:107], v[80:83], v[40:43]
s_or_b64 s[50:51], s[50:51], s[12:13]
s_waitcnt vmcnt(2)
v_cmp_eq_u32 s[14:15], -1, v84
v_mfma_f32_16x16x32_bf16 v[44:47], v[104:107], v[84:87], v[44:47]
s_or_b64 s[50:51], s[50:51], s[14:15]
s_waitcnt vmcnt(1)
v_cmp_eq_u32 s[16:17], -1, v88
v_mfma_f32_16x16x32_bf16 v[40:43], v[108:111], v[88:91], v[40:43]
s_or_b64 s[50:51], s[50:51], s[16:17]
s_waitcnt vmcnt(0)
v_cmp_eq_u32 s[18:19], -1, v92
v_mfma_f32_16x16x32_bf16 v[44:47], v[108:111], v[92:95], v[44:47]
s_or_b64 s[50:51], s[50:51], s[18:19]
s_cmp_lg_u64 s[50:51], 0
s_cbranch_scc1 L_gr_47
s_nop 0
v_cvt_pk_bf16_f32 v48, v40, v41
v_cvt_pk_bf16_f32 v49, v42, v43
s_nop 2
v_cvt_pk_bf16_f32 v52, v44, v45
s_nop 1
v_cvt_pk_bf16_f32 v53, v46, v47
s_nop 0
v_permlane32_swap_b32 v48, v52
s_nop 0
v_permlane32_swap_b32 v49, v53
s_nop 0
v_mov_b32_dpp v48, v52 quad_perm:[0,1,2,3] row_mask:0xf bank_mask:0xc
s_nop 0
v_mov_b32_dpp v49, v53 quad_perm:[0,1,2,3] row_mask:0xf bank_mask:0xc
buffer_store_dwordx4 v[48:51], v8, s[40:43], s62 offen sc1
s_cmp_lt_u32 s53, 11
s_cbranch_scc1 L_done
s_sub_u32 s59, s53, 11
s_lshl3_add_u32 s59, s59, s52
s_cmp_ge_u32 s59, 36
s_cbranch_scc1 L_done
s_lshl_b32 s60, s59, 14
s_lshl_b32 s61, s3, 12
s_add_u32 s60, s60, s61
s_add_u32 s60, s60, 2097152
s_and_b32 s61, s59, 3
s_mul_i32 s61, s61, 144
s_bfe_u32 s62, s59, 0x20002
s_lshl_b32 s62, s62, 5
s_lshr_b32 s63, s59, 4
s_lshl3_add_u32 s62, s63, s62
s_cmp_ge_u32 s59, 32
s_cselect_b32 s62, 128, s62
s_cselect_b32 s63, 16, 32
s_add_u32 s61, s61, s62
s_lshl_b32 s61, s61, 1
v_and_b32 v6, 7, v0
v_lshlrev_b32 v5, 1, v6
v_bfe_u32 v7, v0, 3, 1
v_mul_u32_u24 v8, 0x480, v7
v_add_u32 v5, v5, v8
v_bfe_u32 v8, v0, 4, 1
v_mul_u32_u24 v9, s63, v8
v_add_u32 v5, v5, v9
buffer_load_ushort v31, v5, s[32:35], s61 offen
buffer_load_dwordx4 v[64:67], v3, s[40:43], s60 offen offset:0 sc1
buffer_load_dwordx4 v[68:71], v3, s[40:43], s60 offen offset:1024 sc1
buffer_load_dwordx4 v[72:75], v3, s[40:43], s60 offen offset:2048 sc1
buffer_load_dwordx4 v[76:79], v3, s[40:43], s60 offen offset:3072 sc1
v_lshlrev_b32 v6, 4, v6
v_lshl_add_u32 v8, v8, 1, v7
L_pada12:
s_cbranch_execz L_backa
v_lshl_add_u32 v6, v8, 2, v6
v_add_u32 v6, 143360, v6
s_lshl_b32 s62, s3, 7
s_add_u32 s62, s62, 143360
v_add_u32 v7, s62, v3
v_and_b32 v8, 1, v2
v_lshlrev_b32 v8, 4, v8
v_mov_b32 v9, 0x3f80
v_lshlrev_b32 v8, v8, v9
v_bfe_u32 v9, v2, 1, 1
v_cmp_eq_u32 vcc, 0, v9
s_nop 1
v_cndmask_b32 v10, 0, v8, vcc
s_nop 0
v_cndmask_b32 v11, v8, 0, vcc
L_gc_56:
s_waitcnt vmcnt(3)
v_cmp_ne_u32 s[4:5], s56, v66
v_mfma_f32_16x16x16_bf16 v[40:43], v[10:11], v[64:65], 0
s_waitcnt vmcnt(2)
v_cmp_ne_u32 s[6:7], s56, v70
v_mfma_f32_16x16x16_bf16 v[40:43], v[10:11], v[68:69], v[40:43]
s_or_b64 s[50:51], s[4:5], s[6:7]
s_waitcnt vmcnt(1)
v_cmp_ne_u32 s[8:9], s56, v74
v_mfma_f32_16x16x16_bf16 v[40:43], v[10:11], v[72:73], v[40:43]
s_or_b64 s[50:51], s[50:51], s[8:9]
s_waitcnt vmcnt(0)
v_cmp_ne_u32 s[10:11], s56, v78
v_mfma_f32_16x16x16_bf16 v[40:43], v[10:11], v[76:77], v[40:43]
s_or_b64 s[50:51], s[50:51], s[10:11]
s_cmp_lg_u64 s[50:51], 0
s_cbranch_scc1 L_gr_57
s_nop 4
v_add_f32_dpp v40, v40, v40 row_ror:8 row_mask:0xf bank_mask:0xf
s_nop 3
v_add_f32_dpp v41, v41, v41 row_ror:8 row_mask:0xf bank_mask:0xf
s_nop 2
v_add_f32_dpp v42, v42, v42 row_ror:8 row_mask:0xf bank_mask:0xf
s_nop 1
v_add_f32_dpp v43, v43, v43 row_ror:8 row_mask:0xf bank_mask:0xf
s_mov_b64 exec, 0xff
ds_write_b128 v7, v[40:43]
s_mov_b64 exec, -1
s_waitcnt lgkmcnt(0)
s_barrier
s_cmp_lg_u32 s3, 0
s_cbranch_scc1 L_done
ds_read_b32 v40, v6 offset:0
ds_read_b32 v41, v6 offset:128
ds_read_b32 v42, v6 offset:256
ds_read_b32 v43, v6 offset:384
v_lshlrev_b32 v31, 16, v31
s_waitcnt lgkmcnt(0)
v_add_f32 v40, v40, v41
v_add_f32 v42, v42, v43
v_add_f32 v40, v40, v42
v_add_f32 v40, v40, v31
v_cvt_pk_bf16_f32 v40, v40, v40
s_mov_b32 exec_lo, 0xffffffff
s_mov_b32 exec_hi, 0
buffer_store_short v40, v5, s[44:47], s61 offen
s_cmp_lg_u32 s59, 0
s_cbranch_scc1 L_done
s_mov_b64 exec, 1
buffer_store_dword v4, off, s[40:43], 0 sc1
s_branch L_done
L_gr_23:
s_sub_u32 s57, s57, 1
s_cbranch_scc1 L_end
s_mov_b64 exec, s[4:5]
s_cbranch_execz L_gs_24
buffer_load_dwordx4 v[32:35], v3, s[40:43], s60 offen offset:0 sc1
L_gs_24:
s_mov_b64 exec, s[6:7]
s_cbranch_execz L_gs_25
buffer_load_dwordx4 v[36:39], v3, s[40:43], s60 offen offset:1024 sc1
L_gs_25:
s_mov_b64 exec, s[8:9]
s_cbranch_execz L_gs_26
buffer_load_dwordx4 v[40:43], v3, s[40:43], s60 offen offset:2048 sc1
L_gs_26:
s_mov_b64 exec, s[10:11]
s_cbranch_execz L_gs_27
buffer_load_dwordx4 v[44:47], v3, s[40:43], s60 offen offset:3072 sc1
L_gs_27:
s_mov_b64 exec, s[12:13]
s_cbranch_execz L_gs_28
buffer_load_dwordx4 v[48:51], v3, s[40:43], s61 offen offset:0 sc1
L_gs_28:
s_mov_b64 exec, s[14:15]
s_cbranch_execz L_gs_29
buffer_load_dwordx4 v[52:55], v3, s[40:43], s61 offen offset:1024 sc1
L_gs_29:
s_mov_b64 exec, s[16:17]
s_cbranch_execz L_gs_30
buffer_load_dwordx4 v[56:59], v3, s[40:43], s61 offen offset:2048 sc1
L_gs_30:
s_mov_b64 exec, s[18:19]
s_cbranch_execz L_gs_31
buffer_load_dwordx4 v[60:63], v3, s[40:43], s61 offen offset:3072 sc1
L_gs_31:
s_mov_b64 exec, -1
L_pada13:
s_cbranch_execz L_backa
s_waitcnt vmcnt(0)
s_branch L_gc_22
L_gr_33:
s_sub_u32 s57, s57, 1
s_cbranch_scc1 L_end
s_mov_b64 exec, s[4:5]
s_cbranch_execz L_gs_34
buffer_load_dwordx4 v[64:67], v3, s[40:43], s62 offen offset:0 sc1
L_gs_34:
s_mov_b64 exec, s[6:7]
s_cbranch_execz L_gs_35
buffer_load_dwordx4 v[68:71], v3, s[40:43], s62 offen offset:1024 sc1
L_gs_35:
s_mov_b64 exec, s[8:9]
s_cbranch_execz L_gs_36
buffer_load_dwordx4 v[72:75], v3, s[40:43], s62 offen offset:2048 sc1
L_gs_36:
s_mov_b64 exec, s[10:11]
s_cbranch_execz L_gs_37
buffer_load_dwordx4 v[76:79], v3, s[40:43], s62 offen offset:3072 sc1
L_gs_37:
s_mov_b64 exec, s[12:13]
s_cbranch_execz L_gs_38
buffer_load_dwordx4 v[80:83], v3, s[40:43], s63 offen offset:0 sc1
L_gs_38:
s_mov_b64 exec, s[14:15]
s_cbranch_execz L_gs_39
buffer_load_dwordx4 v[84:87], v3, s[40:43], s63 offen offset:1024 sc1
L_gs_39:
s_mov_b64 exec, s[16:17]
s_cbranch_execz L_gs_40
buffer_load_dwordx4 v[88:91], v3, s[40:43], s63 offen offset:2048 sc1
L_gs_40:
s_mov_b64 exec, s[18:19]
s_cbranch_execz L_gs_41
buffer_load_dwordx4 v[92:95], v3, s[40:43], s63 offen offset:3072 sc1
L_gs_41:
s_mov_b64 exec, s[20:21]
s_cbranch_execz L_gs_42
buffer_load_dwordx4 v[112:115], v5, s[40:43], s64 offen sc1
L_gs_42:
s_mov_b64 exec, -1
s_waitcnt vmcnt(0)
v_cmp_ne_u32 s[4:5], s56, v66
ds_write_b64 v24, v[64:65] offset:16384
v_cmp_ne_u32 s[6:7], s56, v70
ds_write_b64 v24, v[68:69] offset:16896
s_or_b64 s[50:51], s[4:5], s[6:7]
v_cmp_ne_u32 s[8:9], s56, v74
ds_write_b64 v25, v[72:73] offset:16384
s_or_b64 s[50:51], s[50:51], s[8:9]
v_cmp_ne_u32 s[10:11], s56, v78
ds_write_b64 v25, v[76:77] offset:16896
s_or_b64 s[50:51], s[50:51], s[10:11]
v_cmp_ne_u32 s[12:13], s56, v82
ds_write_b64 v26, v[80:81] offset:16384
s_or_b64 s[50:51], s[50:51], s[12:13]
v_cmp_ne_u32 s[14:15], s56, v86
ds_write_b64 v26, v[84:85] offset:16896
s_or_b64 s[50:51], s[50:51], s[14:15]
v_cmp_ne_u32 s[16:17], s56, v90
ds_write_b64 v27, v[88:89] offset:16384
s_or_b64 s[50:51], s[50:51], s[16:17]
v_cmp_ne_u32 s[18:19], s56, v94
ds_write_b64 v27, v[92:93] offset:16896
s_or_b64 s[50:51], s[50:51], s[18:19]
v_cmp_ne_u32 s[20:21], s56, v114
s_or_b64 s[50:51], s[50:51], s[20:21]
s_cmp_lg_u64 s[50:51], 0
s_cbranch_scc1 L_gr_33
s_branch L_gc_32
L_gr_44:
s_sub_u32 s57, s57, 1
s_cbranch_scc1 L_end
s_mov_b64 exec, s[4:5]
buffer_load_dwordx4 v[32:35], v5, s[40:43], s64 offen sc1
s_mov_b64 exec, -1
s_waitcnt vmcnt(0)
s_branch L_gc_43
L_gr_47:
s_sub_u32 s57, s57, 1
s_cbranch_scc1 L_end
s_mov_b64 exec, s[4:5]
s_cbranch_execz L_gs_48
buffer_load_dwordx4 v[64:67], v7, s[40:43], s60 offen offset:0 sc1
L_gs_48:
s_mov_b64 exec, s[6:7]
s_cbranch_execz L_gs_49
buffer_load_dwordx4 v[68:71], v7, s[40:43], s60 offen offset:256 sc1
L_gs_49:
s_mov_b64 exec, s[8:9]
s_cbranch_execz L_gs_50
buffer_load_dwordx4 v[72:75], v7, s[40:43], s60 offen offset:2048 sc1
L_gs_50:
s_mov_b64 exec, s[10:11]
s_cbranch_execz L_gs_51
buffer_load_dwordx4 v[76:79], v7, s[40:43], s60 offen offset:2304 sc1
L_gs_51:
s_mov_b64 exec, s[12:13]
s_cbranch_execz L_gs_52
buffer_load_dwordx4 v[80:83], v7, s[40:43], s61 offen offset:0 sc1
L_gs_52:
s_mov_b64 exec, s[14:15]
s_cbranch_execz L_gs_53
buffer_load_dwordx4 v[84:87], v7, s[40:43], s61 offen offset:256 sc1
L_gs_53:
s_mov_b64 exec, s[16:17]
s_cbranch_execz L_gs_54
buffer_load_dwordx4 v[88:91], v7, s[40:43], s61 offen offset:2048 sc1
L_gs_54:
s_mov_b64 exec, s[18:19]
s_cbranch_execz L_gs_55
buffer_load_dwordx4 v[92:95], v7, s[40:43], s61 offen offset:2304 sc1
L_gs_55:
s_mov_b64 exec, -1
L_pada14:
s_cbranch_execz L_backa
s_waitcnt vmcnt(0)
s_branch L_gc_46
L_gr_57:
s_sub_u32 s57, s57, 1
s_cbranch_scc1 L_end
s_mov_b64 exec, s[4:5]
s_cbranch_execz L_gs_58
buffer_load_dwordx4 v[64:67], v3, s[40:43], s60 offen offset:0 sc1
L_gs_58:
s_mov_b64 exec, s[6:7]
s_cbranch_execz L_gs_59
buffer_load_dwordx4 v[68:71], v3, s[40:43], s60 offen offset:1024 sc1
L_gs_59:
s_mov_b64 exec, s[8:9]
s_cbranch_execz L_gs_60
buffer_load_dwordx4 v[72:75], v3, s[40:43], s60 offen offset:2048 sc1
L_gs_60:
s_mov_b64 exec, s[10:11]
s_cbranch_execz L_gs_61
buffer_load_dwordx4 v[76:79], v3, s[40:43], s60 offen offset:3072 sc1
L_gs_61:
s_mov_b64 exec, -1
s_waitcnt vmcnt(0)
s_branch L_gc_56
L_pv_far:
ds_read_b128 v[96:99], v11 offset:0
ds_read_b128 v[100:103], v11 offset:2048
ds_read_b128 v[104:107], v11 offset:4096
ds_read_b128 v[108:111], v11 offset:6144
ds_read_b128 v[60:63], v9 offset:16
s_waitcnt lgkmcnt(4)
v_mfma_f32_16x16x32_bf16 v[64:67], v[128:131], v[96:99], 0
v_mfma_f32_16x16x32_bf16 v[68:71], v[144:147], v[96:99], 0
s_waitcnt lgkmcnt(0)
v_max3_f32 v29, v60, v61, v62
v_mfma_f32_16x16x32_bf16 v[72:75], v[160:163], v[96:99], 0
v_max_f32 v29, v29, v63
v_sub_f32 v40, v40, v29
v_mfma_f32_16x16x32_bf16 v[76:79], v[176:179], v[96:99], 0
v_sub_f32 v41, v41, v29
v_sub_f32 v42, v42, v29
s_waitcnt lgkmcnt(3)
v_mfma_f32_16x16x32_bf16 v[64:67], v[132:135], v[100:103], v[64:67]
v_sub_f32 v43, v43, v29
v_sub_f32 v44, v44, v29
v_mfma_f32_16x16x32_bf16 v[68:71], v[148:151], v[100:103], v[68:71]
v_sub_f32 v45, v45, v29
v_sub_f32 v46, v46, v29
v_mfma_f32_16x16x32_bf16 v[72:75], v[164:167], v[100:103], v[72:75]
v_sub_f32 v47, v47, v29
v_exp_f32 v40, v40
v_mfma_f32_16x16x32_bf16 v[76:79], v[180:183], v[100:103], v[76:79]
v_exp_f32 v41, v41
v_exp_f32 v42, v42
s_waitcnt lgkmcnt(2)
v_mfma_f32_16x16x32_bf16 v[64:67], v[136:139], v[104:107], v[64:67]
v_exp_f32 v43, v43
v_exp_f32 v44, v44
v_mfma_f32_16x16x32_bf16 v[68:71], v[152:155], v[104:107], v[68:71]
v_exp_f32 v45, v45
v_exp_f32 v46, v46
v_mfma_f32_16x16x32_bf16 v[72:75], v[168:171], v[104:107], v[72:75]
v_exp_f32 v47, v47
v_cvt_pk_bf16_f32 v48, v40, v41
v_mfma_f32_16x16x32_bf16 v[76:79], v[184:187], v[104:107], v[76:79]
v_cvt_pk_bf16_f32 v49, v42, v43
v_cvt_pk_bf16_f32 v50, v44, v45
s_waitcnt lgkmcnt(1)
v_mfma_f32_16x16x32_bf16 v[64:67], v[140:143], v[108:111], v[64:67]
v_cvt_pk_bf16_f32 v51, v46, v47
ds_write_b128 v8, v[48:51] offset:1024
v_mfma_f32_16x16x32_bf16 v[68:71], v[156:159], v[108:111], v[68:71]
v_mfma_f32_16x16x32_bf16 v[72:75], v[172:175], v[108:111], v[72:75]
v_mfma_f32_16x16x32_bf16 v[76:79], v[188:191], v[108:111], v[76:79]
v_mfma_f32_16x16x32_bf16 v[80:83], v[192:195], v[96:99], 0
v_mfma_f32_16x16x32_bf16 v[84:87], v[208:211], v[96:99], 0
v_mfma_f32_16x16x32_bf16 v[88:91], v[224:227], v[96:99], 0
v_mfma_f32_16x16x32_bf16 v[92:95], v[240:243], v[96:99], 0
s_waitcnt lgkmcnt(0)
s_barrier
v_mfma_f32_16x16x32_bf16 v[80:83], v[196:199], v[100:103], v[80:83]
ds_read_b128 v[112:115], v11 offset:1024
ds_read_b128 v[116:119], v11 offset:3072
ds_read_b128 v[120:123], v11 offset:5120
ds_read_b128 v[124:127], v11 offset:7168
v_mfma_f32_16x16x32_bf16 v[84:87], v[212:215], v[100:103], v[84:87]
v_cvt_pk_bf16_f32 v64, v64, v65
v_mfma_f32_16x16x32_bf16 v[88:91], v[228:231], v[100:103], v[88:91]
v_cvt_pk_bf16_f32 v65, v66, v67
v_mfma_f32_16x16x32_bf16 v[92:95], v[244:247], v[100:103], v[92:95]
v_cvt_pk_bf16_f32 v66, v68, v69
v_mfma_f32_16x16x32_bf16 v[80:83], v[200:203], v[104:107], v[80:83]
v_cvt_pk_bf16_f32 v67, v70, v71
v_mfma_f32_16x16x32_bf16 v[84:87], v[216:219], v[104:107], v[84:87]
v_min_u32 v64, -2, v64
v_mfma_f32_16x16x32_bf16 v[88:91], v[232:235], v[104:107], v[88:91]
buffer_store_dwordx4 v[64:67], v30, s[40:43], s60 offen offset:0 sc1
v_mfma_f32_16x16x32_bf16 v[92:95], v[248:251], v[104:107], v[92:95]
v_cvt_pk_bf16_f32 v72, v72, v73
v_mfma_f32_16x16x32_bf16 v[80:83], v[204:207], v[108:111], v[80:83]
v_cvt_pk_bf16_f32 v73, v74, v75
v_mfma_f32_16x16x32_bf16 v[84:87], v[220:223], v[108:111], v[84:87]
v_cvt_pk_bf16_f32 v74, v76, v77
v_mfma_f32_16x16x32_bf16 v[88:91], v[236:239], v[108:111], v[88:91]
v_cvt_pk_bf16_f32 v75, v78, v79
v_mfma_f32_16x16x32_bf16 v[92:95], v[252:255], v[108:111], v[92:95]
v_min_u32 v72, -2, v72
s_waitcnt lgkmcnt(0)
v_mfma_f32_16x16x32_bf16 v[16:19], v[24:27], v[96:99], 0
buffer_store_dwordx4 v[72:75], v30, s[40:43], s60 offen offset:128 sc1
v_mfma_f32_16x16x32_bf16 v[20:23], v[24:27], v[112:115], 0
v_mfma_f32_16x16x32_bf16 v[16:19], v[24:27], v[100:103], v[16:19]
v_cvt_pk_bf16_f32 v80, v80, v81
v_cvt_pk_bf16_f32 v81, v82, v83
v_mfma_f32_16x16x32_bf16 v[20:23], v[24:27], v[116:119], v[20:23]
v_cvt_pk_bf16_f32 v82, v84, v85
v_cvt_pk_bf16_f32 v83, v86, v87
v_mfma_f32_16x16x32_bf16 v[16:19], v[24:27], v[104:107], v[16:19]
v_min_u32 v80, -2, v80
buffer_store_dwordx4 v[80:83], v30, s[40:43], s60 offen offset:256 sc1
v_mfma_f32_16x16x32_bf16 v[20:23], v[24:27], v[120:123], v[20:23]
v_cvt_pk_bf16_f32 v88, v88, v89
v_cvt_pk_bf16_f32 v89, v90, v91
v_mfma_f32_16x16x32_bf16 v[16:19], v[24:27], v[108:111], v[16:19]
v_cvt_pk_bf16_f32 v90, v92, v93
v_cvt_pk_bf16_f32 v91, v94, v95
v_mfma_f32_16x16x32_bf16 v[20:23], v[24:27], v[124:127], v[20:23]
v_min_u32 v88, -2, v88
buffer_store_dwordx4 v[88:91], v30, s[40:43], s60 offen offset:384 sc1
v_mfma_f32_16x16x32_bf16 v[32:35], v[128:131], v[112:115], 0
v_mfma_f32_16x16x32_bf16 v[36:39], v[144:147], v[112:115], 0
v_mfma_f32_16x16x32_bf16 v[40:43], v[160:163], v[112:115], 0
s_mov_b32 s48, 0xffff
s_mov_b32 s49, s48
v_mfma_f32_16x16x32_bf16 v[44:47], v[176:179], v[112:115], 0
v_cndmask_b32 v12, v29, v28, s[48:49]
v_cndmask_b32 v13, v20, v16, s[48:49]
v_mfma_f32_16x16x32_bf16 v[32:35], v[132:135], v[116:119], v[32:35]
v_mov_b32 v14, v4
v_mov_b32 v15, v4
v_mfma_f32_16x16x32_bf16 v[36:39], v[148:151], v[116:119], v[36:39]
v_mfma_f32_16x16x32_bf16 v[40:43], v[164:167], v[116:119], v[40:43]
v_mfma_f32_16x16x32_bf16 v[44:47], v[180:183], v[116:119], v[44:47]
v_mfma_f32_16x16x32_bf16 v[32:35], v[136:139], v[120:123], v[32:35]
v_mfma_f32_16x16x32_bf16 v[36:39], v[152:155], v[120:123], v[36:39]
v_mfma_f32_16x16x32_bf16 v[40:43], v[168:171], v[120:123], v[40:43]
v_mfma_f32_16x16x32_bf16 v[44:47], v[184:187], v[120:123], v[44:47]
v_mfma_f32_16x16x32_bf16 v[32:35], v[140:143], v[124:127], v[32:35]
v_mfma_f32_16x16x32_bf16 v[36:39], v[156:159], v[124:127], v[36:39]
v_mfma_f32_16x16x32_bf16 v[40:43], v[172:175], v[124:127], v[40:43]
v_mfma_f32_16x16x32_bf16 v[44:47], v[188:191], v[124:127], v[44:47]
v_mfma_f32_16x16x32_bf16 v[48:51], v[192:195], v[112:115], 0
v_mfma_f32_16x16x32_bf16 v[52:55], v[208:211], v[112:115], 0
v_mfma_f32_16x16x32_bf16 v[56:59], v[224:227], v[112:115], 0
s_nop 1
v_cvt_pk_bf16_f32 v32, v32, v33
v_mfma_f32_16x16x32_bf16 v[60:63], v[240:243], v[112:115], 0
v_cvt_pk_bf16_f32 v33, v34, v35
v_mfma_f32_16x16x32_bf16 v[48:51], v[196:199], v[116:119], v[48:51]
v_cvt_pk_bf16_f32 v34, v36, v37
v_mfma_f32_16x16x32_bf16 v[52:55], v[212:215], v[116:119], v[52:55]
v_cvt_pk_bf16_f32 v35, v38, v39
v_mfma_f32_16x16x32_bf16 v[56:59], v[228:231], v[116:119], v[56:59]
v_min_u32 v32, -2, v32
v_mfma_f32_16x16x32_bf16 v[60:63], v[244:247], v[116:119], v[60:63]
buffer_store_dwordx4 v[32:35], v30, s[40:43], s61 offen offset:0 sc1
v_mfma_f32_16x16x32_bf16 v[48:51], v[200:203], v[120:123], v[48:51]
v_cvt_pk_bf16_f32 v40, v40, v41
v_mfma_f32_16x16x32_bf16 v[52:55], v[216:219], v[120:123], v[52:55]
v_cvt_pk_bf16_f32 v41, v42, v43
v_mfma_f32_16x16x32_bf16 v[56:59], v[232:235], v[120:123], v[56:59]
v_cvt_pk_bf16_f32 v42, v44, v45
v_mfma_f32_16x16x32_bf16 v[60:63], v[248:251], v[120:123], v[60:63]
v_cvt_pk_bf16_f32 v43, v46, v47
v_mfma_f32_16x16x32_bf16 v[48:51], v[204:207], v[124:127], v[48:51]
v_min_u32 v40, -2, v40
v_mfma_f32_16x16x32_bf16 v[52:55], v[220:223], v[124:127], v[52:55]
buffer_store_dwordx4 v[40:43], v30, s[40:43], s61 offen offset:128 sc1
v_mfma_f32_16x16x32_bf16 v[56:59], v[236:239], v[124:127], v[56:59]
v_mfma_f32_16x16x32_bf16 v[60:63], v[252:255], v[124:127], v[60:63]
s_nop 2
v_cvt_pk_bf16_f32 v48, v48, v49
s_nop 1
v_cvt_pk_bf16_f32 v49, v50, v51
s_nop 2
v_cvt_pk_bf16_f32 v50, v52, v53
s_nop 1
v_cvt_pk_bf16_f32 v51, v54, v55
v_min_u32 v48, -2, v48
buffer_store_dwordx4 v[48:51], v30, s[40:43], s61 offen offset:256 sc1
s_nop 0
v_cvt_pk_bf16_f32 v56, v56, v57
v_cvt_pk_bf16_f32 v57, v58, v59
v_cvt_pk_bf16_f32 v58, v60, v61
v_cvt_pk_bf16_f32 v59, v62, v63
v_min_u32 v56, -2, v56
buffer_store_dwordx4 v[56:59], v30, s[40:43], s61 offen offset:384 sc1
s_waitcnt vmcnt(0)
s_mov_b32 exec_lo, 0xffffffff
s_mov_b32 exec_hi, 0
buffer_store_dwordx4 v[12:15], v3, s[40:43], s62 offen sc1
s_mov_b64 exec, -1
s_branch L_pv_done
L_done:
L_end:
s_endpgm
.section .rodata,"a"
.p2align 6
.amdhsa_kernel parallel_sum__compressed_kv_cla__dense_activation_silu__decode_kernel
  .amdhsa_next_free_vgpr 512
  .amdhsa_next_free_sgpr 102
  .amdhsa_accum_offset 256
  .amdhsa_group_segment_fixed_size 0
  .amdhsa_kernarg_size 96
  .amdhsa_user_sgpr_count 2
  .amdhsa_user_sgpr_kernarg_segment_ptr 1
  .amdhsa_system_sgpr_workgroup_id_x 1
.end_amdhsa_kernel
```
